```python
import torch

def _softmax(x, axis=-1):
    return torch.softmax(x, dim=axis)
def _gelu(x):
    return torch.nn.functional.gelu(x, approximate="tanh")
def _silu(x):
    return torch.nn.functional.silu(x)
def _sigmoid(x):
    return torch.sigmoid(x)
def _layernorm(x, axis=-1, eps=1e-5):
    m = x.mean(dim=axis, keepdim=True)
    v = x.var(dim=axis, keepdim=True, unbiased=False)
    return (x - m) / torch.sqrt(v + eps)
def _scatter_add(tgt, idx, src, axis=0):
    return tgt.clone().index_add_(axis, idx, src)
def _segment_sum(src, seg, n):
    out = torch.zeros((n,) + src.shape[1:], dtype=src.dtype)
    return out.index_add_(0, seg, src)
def _pad(x, pw):
    flat = tuple(v for pair in reversed(pw) for v in pair)
    return torch.nn.functional.pad(x, flat)

kernel_name = 'standalone__modern_conv_block_slak__vision'

def setup_inputs():

    _w = (lambda a: (lambda t: t.to(torch.bfloat16) if t.is_floating_point() else t)(torch.as_tensor(a)))
    H = W = 224
    C = 96
    K = 5
    return {
        "x": _w((lambda *s: torch.randn(*s, dtype=torch.bfloat16) * 0.05)(1, H, W, C)),
        "dw": _w((lambda *s: torch.randn(*s, dtype=torch.bfloat16) * 0.05)(K, K, C)),
        "w1": _w((lambda *s: torch.randn(*s, dtype=torch.bfloat16) * 0.05)(C, 4 * C)),
        "w2": _w((lambda *s: torch.randn(*s, dtype=torch.bfloat16) * 0.05)(4 * C, C)),
        "grn_g": _w((lambda *s: torch.randn(*s, dtype=torch.bfloat16) * 0.05)(4 * C)),
        "grn_b": _w((lambda *s: torch.randn(*s, dtype=torch.bfloat16) * 0.05)(4 * C)),
    }

def reference(x, dw, w1, w2, grn_g, grn_b):
    B, H, W, C = x.shape
    K = dw.shape[0]
    pad = K // 2
    xp = _pad(x, ((0,0),(pad,pad),(pad,pad),(0,0)))
    out = torch.zeros_like(x)
    for i in range(K):
        for j in range(K):
            out = out + xp[:, i:i+H, j:j+W, :] * dw[i, j][None, None, None, :]
    h = _layernorm(out, axis=-1)
    h = _gelu(h @ w1)
    gx = torch.sqrt((h * h).sum(axis=(1, 2), keepdims=True) + 1e-6)
    nx = gx / (gx.mean(axis=-1, keepdims=True) + 1e-6)
    h = grn_g[None, None, None, :] * (h * nx) + grn_b[None, None, None, :] + h
    return x + h @ w2
```

```asm
; @launch grid=(256,1,1) block=(256,1,1) lds=163840
.amdgcn_target "amdgcn-amd-amdhsa--gfx950"
.text
.globl standalone__modern_conv_block_slak__vision_kernel
.p2align 12
.p2align 8
.type standalone__modern_conv_block_slak__vision_kernel,@function
standalone__modern_conv_block_slak__vision_kernel:
  s_cmp_ge_u32 s2, 256
  s_cbranch_scc1 L_end
  s_load_dwordx16 s[4:19], s[0:1], 0
  s_load_dwordx2 s[20:21], s[0:1], 64
  v_lshrrev_b32 v5, 6, v0
  v_and_b32 v6, 63, v0
  v_readfirstlane_b32 s44, v5
  v_lshlrev_b32 v1, 4, v6
  v_and_b32 v2, 15, v6
  v_lshrrev_b32 v3, 4, v6
  s_getpc_b64 s[68:69]
L_pcrefa:
  s_sub_u32 s68, s68, L_pcrefa-standalone__modern_conv_block_slak__vision_kernel
  s_subb_u32 s69, s69, 0
  s_lshr_b32 s66, s2, 3
  s_lshl_b32 s66, s66, 2
  s_add_u32 s66, s66, s44
  s_sub_u32 s66, s66, 0
  s_cbranch_scc1 L_notoucha
  s_add_u32 s66, s66, 0
  s_lshl_b32 s66, s66, 10
  s_cmp_ge_u32 s66, 16384
  s_cbranch_scc1 L_notoucha
  s_min_u32 s66, s66, L_end-standalone__modern_conv_block_slak__vision_kernel-1020
  v_add_u32 v20, s66, v1
  v_mov_b32 v23, s69
  v_add_co_u32 v22, vcc, s68, v20
  s_nop 1
  v_addc_co_u32 v23, vcc, 0, v23, vcc
  global_load_dwordx4 a[248:251], v[22:23], off
L_notoucha:
  s_and_b32 s66, s2, 7
  s_lshr_b32 s67, s2, 3
  s_and_b32 s68, s66, 3
  s_lshl_b32 s68, s68, 2
  s_and_b32 s69, s67, 3
  s_add_u32 s68, s68, s69
  s_mul_i32 s45, s68, 14
  s_lshr_b32 s66, s66, 2
  s_lshl_b32 s66, s66, 3
  s_lshr_b32 s67, s67, 2
  s_add_u32 s66, s66, s67
  s_mul_i32 s46, s66, 14
  s_mov_b32 s64, 0x40000000
  s_lshl_b32 s73, s44, 6
  s_min_u32 s73, s73, 176
  v_add_u32_e64 v11, s73, v6
  v_mul_u32_u24 v7, 5042, v11
  v_lshrrev_b32 v7, 16, v7
  v_mul_u32_u24 v8, 13, v7
  v_sub_u32 v8, v11, v8
  s_sub_i32 s66, s45, 2
  v_add_u32_e64 v9, s66, v7
  v_mul_u32_u24 v10, 192, v9
  v_lshl_add_u32 v10, v8, 4, v10
  s_movk_i32 s67, 224
  v_cmp_gt_u32 vcc, s67, v9
  v_cmp_gt_u32 s[68:69], 12, v8
  s_movk_i32 s67, 234
  v_cmp_gt_u32 s[70:71], s67, v11
  v_mov_b32 v11, s64
  s_and_b64 vcc, vcc, s[68:69]
  s_and_b64 vcc, vcc, s[70:71]
  v_cndmask_b32 v10, v11, v10, vcc
  s_lshl_b32 s73, s73, 4
  s_add_u32 s65, s73, 84480
  s_sub_i32 s48, s46, 2
  s_mul_i32 s48, s48, 43008
  s_waitcnt lgkmcnt(0)
  s_mov_b32 s28, s6
  s_nop 0
  s_and_b32 s29, s7, 0xffff
  s_mov_b32 s30, 4800
  s_mov_b32 s31, 0x20000
  s_mov_b32 s24, s4
  s_nop 0
  s_and_b32 s25, s5, 0xffff
  s_mov_b32 s26, 9633792
  s_mov_b32 s27, 0x20000
  s_lshl_b32 s72, s44, 10
  s_add_u32 m0, s72, 154560
  v_add_u32 v12, s72, v1
  buffer_load_dwordx4 v12, s[28:31], 0 offen lds
  s_cmp_lg_u32 s44, 0
  s_cbranch_scc1 L_nodw4
  s_mov_b32 m0, 158656
  v_add_u32 v12, 4096, v1
  buffer_load_dwordx4 v12, s[28:31], 0 offen lds
L_nodw4:
  s_add_u32 s67, s48, 0
  s_cmp_eq_u32 s46, 0
  s_cselect_b32 s67, s64, s67
  s_add_u32 m0, s65, 0
  s_nop 0
  buffer_load_dwordx4 v10, s[24:27], s67 offen nt lds
  s_add_u32 s67, s48, 43008
  s_cmp_eq_u32 s46, 0
  s_cselect_b32 s67, s64, s67
  s_add_u32 m0, s65, 3840
  s_nop 0
  buffer_load_dwordx4 v10, s[24:27], s67 offen nt lds
  s_add_u32 m0, s65, 7680
  s_add_u32 s67, s48, 86016
  buffer_load_dwordx4 v10, s[24:27], s67 offen nt lds
  s_add_u32 m0, s65, 11520
  s_add_u32 s67, s48, 129024
  buffer_load_dwordx4 v10, s[24:27], s67 offen nt lds
  s_add_u32 m0, s65, 15360
  s_add_u32 s67, s48, 172032
  buffer_load_dwordx4 v10, s[24:27], s67 offen nt lds
  s_add_u32 m0, s65, 19200
  s_add_u32 s67, s48, 215040
  buffer_load_dwordx4 v10, s[24:27], s67 offen nt lds
  s_add_u32 m0, s65, 23040
  s_add_u32 s67, s48, 258048
  buffer_load_dwordx4 v10, s[24:27], s67 offen nt lds
  s_add_u32 m0, s65, 26880
  s_add_u32 s67, s48, 301056
  buffer_load_dwordx4 v10, s[24:27], s67 offen nt lds
  s_load_dword s47, s[20:21], 0
  s_mov_b32 s32, s8
  s_nop 0
  s_and_b32 s33, s9, 0xffff
  s_mov_b32 s34, 73728
  s_mov_b32 s35, 0x20000
  s_mov_b32 s36, s10
  s_nop 0
  s_and_b32 s37, s11, 0xffff
  s_mov_b32 s38, 73728
  s_mov_b32 s39, 0x20000
  s_mov_b32 s40, s16
  s_nop 0
  s_and_b32 s41, s17, 0xffff
  s_mov_b32 s42, 9633792
  s_mov_b32 s43, 0x20000
  s_mul_i32 s76, s44, 19200
  s_add_u32 s76, s76, 0
  s_nop 0
  s_mul_i32 s77, s44, 18432
  s_mov_b32 s50, 0x409d30fc
  s_mov_b32 s51, 0x409d30fc
  s_mov_b32 s52, 0x11111111
  s_mov_b32 s53, 0x11111111
  s_mov_b32 s54, 0x22222222
  s_mov_b32 s55, 0x22222222
  s_mov_b32 s56, 0x44444444
  s_mov_b32 s57, 0x44444444
  s_mov_b32 s58, 0x88888888
  s_mov_b32 s59, 0x88888888
  s_mov_b32 s60, 0x00f0000f
  s_mov_b32 s61, 0xf0000f00
  s_mov_b32 s62, 0x000f000f
  s_mov_b32 s63, 0x000f000f
  v_subrev_u32 v7, 32, v1
  v_cmp_gt_u32 vcc, 48, v6
  v_subrev_u32 v8, 48, v6
  s_nop 0
  v_cndmask_b32 v7, v7, v1, vcc
  v_cmp_gt_u32 vcc, 2, v8
  s_nop 1
  v_cndmask_b32 v7, v7, v11, vcc
  v_mov_b32 v18, 0x3f803f80
  v_accvgpr_write_b32 a92, v18
  v_accvgpr_write_b32 a93, v18
  v_accvgpr_write_b32 a94, v18
  v_accvgpr_write_b32 a95, v18
  v_and_b32 v14, 1, v2
  v_lshlrev_b32 v14, 4, v14
  v_mov_b32 v15, 0x3f80
  v_lshlrev_b32 v14, v14, v15
  v_lshrrev_b32 v15, 2, v2
  v_cmp_eq_u32_e64 vcc, v15, v3
  v_bfe_u32 v15, v2, 1, 1
  s_nop 0
  v_cndmask_b32 v14, 0, v14, vcc
  v_cmp_eq_u32 vcc, 0, v15
  v_mov_b32 v18, 0
  s_nop 0
  v_cndmask_b32 v16, 0, v14, vcc
  v_cndmask_b32 v17, v14, 0, vcc
  v_accvgpr_write_b32 a84, v16
  v_accvgpr_write_b32 a85, v17
  v_accvgpr_write_b32 a86, v18
  v_accvgpr_write_b32 a87, v18
  v_accvgpr_write_b32 a88, v18
  v_accvgpr_write_b32 a89, v18
  v_accvgpr_write_b32 a90, v16
  v_accvgpr_write_b32 a91, v17
  v_mov_b64 v[12:13], 0
  v_mov_b64 v[14:15], 0
  v_lshlrev_b32_e64 v16, 4, v0
  v_add_u32 v17, 159360, v16
  v_add_u32 v16, 153600, v16
  v_cmp_gt_u32 vcc, 180, v0
  s_nop 1
  s_and_saveexec_b64 s[66:67], vcc
  s_cbranch_execz L_noz0
  ds_write_b128 v17, v[12:15]
L_noz0:
  s_mov_b64 exec, s[66:67]
  v_cmp_gt_u32 vcc, 60, v0
  s_nop 1
  s_and_saveexec_b64 s[66:67], vcc
  s_cbranch_execz L_noz
  ds_write_b128 v16, v[12:15]
L_noz:
  s_mov_b64 exec, s[66:67]
  v_lshrrev_b32 v100, 3, v2
  v_and_b32 v101, 7, v2
  v_lshrrev_b32 v102, 1, v3
  v_sub_u32 v102, v102, v100
  v_add_u32 v102, 1, v102
  v_mul_u32_u24 v102, 960, v102
  v_and_b32_e64 v103, 1, v3
  v_mul_u32_u24 v103, 384, v103
  v_add_u32_e64 v102, v102, v103
  v_lshl_add_u32 v102, v101, 1, v102
  s_mul_i32 s66, s44, 48
  s_add_u32 s67, s66, 153600
  v_add_u32 v240, s67, v102
  v_lshlrev_b32 v103, 1, v3
  v_sub_u32 v103, v103, v100
  v_add_u32_e64 v103, 1, v103
  v_mul_u32_u24 v103, 960, v103
  v_lshl_add_u32 v103, v101, 1, v103
  s_add_u32 s67, s67, 768
  v_add_u32 v241, s67, v103
  v_cmp_gt_u32 vcc, 4, v101
  v_and_b32 v104, 3, v101
  v_add_u32 v105, 1, v104
  v_and_b32_e64 v105, 3, v105
  v_lshl_or_b32 v104, v105, 2, v104
  s_movk_i32 s68, 0x1111
  v_mul_u32_u24 v92, s68, v104
  v_cndmask_b32 v242, 0, -1, vcc
  v_not_b32 v243, v242
  v_add_u32 v106, v2, v3
  v_mul_u32_u24 v106, 208, v106
  s_add_u32 s67, s66, 84480
  v_add_u32_e64 v93, s67, v106
  v_mul_u32_u24 v106, 208, v2
  s_add_u32 s68, s67, 832
  v_add_u32_e64 v108, s68, v106
  v_mul_u32_u24 v107, 3840, v3
  v_add_u32 v94, v108, v107
  v_min_u32 v107, 1, v3
  v_add_u32_e64 v107, 4, v107
  v_mul_u32_u24 v107, 3840, v107
  v_add_u32 v95, v108, v107
  v_lshrrev_b32 v107, 1, v3
  v_mul_u32_u24 v107, 3328, v107
  v_add_u32 v106, v106, v107
  v_and_b32 v107, 1, v3
  v_lshl_add_u32 v106, v107, 3, v106
  s_add_u32 s67, s66, 76800
  v_add_u32 v96, s67, v106
  v_min_u32 v100, 3, v2
  v_mul_u32_u24 v101, 4682, v100
  v_lshrrev_b32 v101, 16, v101
  v_mul_u32_u24 v102, 14, v101
  v_sub_u32_e64 v100, v100, v102
  v_mul_u32_u24 v97, 208, v100
  v_lshl_add_u32 v97, v3, 3, v97
  v_lshrrev_b32_e64 v102, 1, v101
  v_mul_u32_u24 v102, 7680, v102
  v_add_u32 v97, v97, v102
  v_and_b32 v102, 1, v101
  v_mul_u32_u24 v102, 3328, v102
  v_add_u32_e64 v97, v97, v102
  v_add_u32 v97, 76800, v97
  s_lshl_b32 s66, s44, 4
  s_add_u32 s66, s66, 4
  v_add_u32_e64 v100, s66, v2
  v_mul_u32_u24 v101, 4682, v100
  v_lshrrev_b32 v101, 16, v101
  v_mul_u32_u24 v102, 14, v101
  v_sub_u32_e64 v100, v100, v102
  v_mul_u32_u24 v98, 208, v100
  v_lshl_add_u32 v98, v3, 3, v98
  v_lshrrev_b32_e64 v102, 1, v101
  v_mul_u32_u24 v102, 7680, v102
  v_add_u32 v98, v98, v102
  v_and_b32 v102, 1, v101
  v_mul_u32_u24 v102, 3328, v102
  v_add_u32_e64 v98, v98, v102
  v_add_u32 v98, 76800, v98
  v_mul_u32_u24 v238, 208, v100
  v_mul_u32_u24 v102, 3840, v101
  v_add_u32_e64 v238, v238, v102
  v_lshl_add_u32 v238, v3, 4, v238
  v_add_u32 v238, 92576, v238
  v_add_u32_e64 v101, s46, v101
  v_mul_u32_u24 v101, 224, v101
  v_add3_u32 v100, v100, v101, s45
  v_mul_u32_u24 v100, 192, v100
  v_lshl_add_u32 v100, v3, 4, v100
  v_accvgpr_write_b32 a11, v100
  s_lshl_b32 s66, s44, 4
  s_add_u32 s66, s66, 68
  v_add_u32 v100, s66, v2
  v_mul_u32_u24 v101, 4682, v100
  v_lshrrev_b32 v101, 16, v101
  v_mul_u32_u24 v102, 14, v101
  v_sub_u32_e64 v100, v100, v102
  v_mul_u32_u24 v99, 208, v100
  v_lshl_add_u32 v99, v3, 3, v99
  v_lshrrev_b32_e64 v102, 1, v101
  v_mul_u32_u24 v102, 7680, v102
  v_add_u32 v99, v99, v102
  v_and_b32 v102, 1, v101
  v_mul_u32_u24 v102, 3328, v102
  v_add_u32_e64 v99, v99, v102
  v_add_u32 v99, 76800, v99
  v_mul_u32_u24 v239, 208, v100
  v_mul_u32_u24 v102, 3840, v101
  v_add_u32_e64 v239, v239, v102
  v_lshl_add_u32 v239, v3, 4, v239
  v_add_u32 v239, 92576, v239
  v_add_u32_e64 v101, s46, v101
  v_mul_u32_u24 v101, 224, v101
  v_add3_u32 v100, v100, v101, s45
  v_mul_u32_u24 v100, 192, v100
  v_lshl_add_u32 v100, v3, 4, v100
  v_accvgpr_write_b32 a12, v100
  s_lshl_b32 s66, s44, 4
  s_add_u32 s66, s66, 132
  v_add_u32 v100, s66, v2
  v_mul_u32_u24 v101, 4682, v100
  v_lshrrev_b32 v101, 16, v101
  v_mul_u32_u24 v102, 14, v101
  v_sub_u32_e64 v100, v100, v102
  v_mul_u32_u24 v5, 208, v100
  v_lshl_add_u32 v5, v3, 3, v5
  v_lshrrev_b32_e64 v102, 1, v101
  v_mul_u32_u24 v102, 7680, v102
  v_add_u32 v5, v5, v102
  v_and_b32 v102, 1, v101
  v_mul_u32_u24 v102, 3328, v102
  v_add_u32_e64 v5, v5, v102
  v_add_u32 v5, 76800, v5
  v_mul_u32_u24 v204, 208, v100
  v_mul_u32_u24 v102, 3840, v101
  v_add_u32_e64 v204, v204, v102
  v_lshl_add_u32 v204, v3, 4, v204
  v_add_u32 v204, 92576, v204
  v_add_u32_e64 v101, s46, v101
  v_mul_u32_u24 v101, 224, v101
  v_add3_u32 v100, v100, v101, s45
  v_mul_u32_u24 v100, 192, v100
  v_lshl_add_u32 v100, v3, 4, v100
  v_accvgpr_write_b32 a13, v100
  v_lshrrev_b32 v103, 4, v1
  v_add_u32 v104, 0, v103
  v_mul_u32_u24 v105, 5462, v104
  v_lshrrev_b32 v105, 16, v105
  v_mul_u32_u24 v106, 12, v105
  v_sub_u32 v106, v104, v106
  v_lshrrev_b32 v107, 3, v105
  v_mul_u32_u24 v107, 3, v107
  v_xor_b32 v106, v106, v107
  v_mul_u32_u24 v105, 192, v105
  v_lshl_add_u32 v105, v106, 4, v105
  v_subrev_u32_e64 v105, 0, v105
  v_accvgpr_write_b32 a0, v105
  v_add_u32_e64 v104, 64, v103
  v_mul_u32_u24 v105, 5462, v104
  v_lshrrev_b32 v105, 16, v105
  v_mul_u32_u24 v106, 12, v105
  v_sub_u32 v106, v104, v106
  v_lshrrev_b32 v107, 3, v105
  v_mul_u32_u24 v107, 3, v107
  v_xor_b32 v106, v106, v107
  v_mul_u32_u24 v105, 192, v105
  v_lshl_add_u32 v105, v106, 4, v105
  v_subrev_u32 v105, 1024, v105
  v_accvgpr_write_b32 a1, v105
  v_add_u32 v104, 128, v103
  v_mul_u32_u24 v105, 5462, v104
  v_lshrrev_b32 v105, 16, v105
  v_mul_u32_u24 v106, 12, v105
  v_sub_u32 v106, v104, v106
  v_lshrrev_b32 v107, 3, v105
  v_mul_u32_u24 v107, 3, v107
  v_xor_b32 v106, v106, v107
  v_mul_u32_u24 v105, 192, v105
  v_lshl_add_u32 v105, v106, 4, v105
  v_subrev_u32 v105, 2048, v105
  v_accvgpr_write_b32 a2, v105
  s_add_u32 s66, s44, 0
  s_and_b32 s66, s66, 3
  s_mul_i32 s66, s66, 3072
  v_add_u32_e64 v106, s66, v1
  v_accvgpr_write_b32 a14, v106
  s_add_u32 s66, s44, 1
  s_and_b32 s66, s66, 3
  s_mul_i32 s66, s66, 3072
  v_add_u32_e64 v106, s66, v1
  v_accvgpr_write_b32 a15, v106
  s_add_u32 s66, s44, 2
  s_and_b32 s66, s66, 3
  s_mul_i32 s66, s66, 3072
  v_add_u32_e64 v106, s66, v1
  v_accvgpr_write_b32 a16, v106
  s_add_u32 s66, s44, 3
  s_and_b32 s66, s66, 3
  s_mul_i32 s66, s66, 3072
  v_add_u32_e64 v106, s66, v1
  v_accvgpr_write_b32 a17, v106
  s_mul_i32 s66, s44, 3072
  v_add_u32_e64 v106, s66, v1
  v_accvgpr_write_b32 a18, v106
  s_mul_i32 s66, s44, 1536
  s_add_u32 s66, s66, 84992
  v_mul_u32_u24 v106, 384, v2
  v_lshl_add_u32 v106, v3, 5, v106
  v_add_u32_e64 v106, s66, v106
  v_accvgpr_write_b32 a19, v106
  s_mul_i32 s66, s44, 384
  s_add_u32 s66, s66, 161280
  v_lshlrev_b32 v106, 4, v3
  v_add_u32 v106, s66, v106
  v_accvgpr_write_b32 a20, v106
  s_mul_i32 s66, s44, 18432
  s_add_u32 s66, s66, 76800
  v_lshrrev_b32 v103, 3, v2
  v_mul_u32_u24 v103, 3, v103
  v_xor_b32_e64 v103, v103, v3
  v_mul_u32_u24 v106, 192, v2
  v_lshl_add_u32 v106, v103, 4, v106
  v_add_u32_e64 v106, s66, v106
  v_accvgpr_write_b32 a21, v106
  s_mul_i32 s66, s44, 192
  s_add_u32 s66, s66, 154368
  v_lshlrev_b32 v106, 3, v3
  v_add_u32 v106, s66, v106
  v_accvgpr_write_b32 a22, v106
  v_lshrrev_b32_e64 v106, 3, v1
  v_add_u32 v106, 153600, v106
  v_accvgpr_write_b32 a23, v106
  v_and_b32 v100, 3, v2
  s_mul_i32 s66, s44, 6
  v_add_u32 v100, s66, v100
  v_lshrrev_b32 v101, 2, v2
  v_and_b32 v102, 1, v101
  v_lshrrev_b32 v101, 1, v101
  v_lshl_or_b32 v101, v102, 1, v101
  v_lshl_add_u32 v101, v3, 2, v101
  v_lshlrev_b32_e64 v101, 2, v101
  s_mul_i32 s66, s44, 1536
  s_add_u32 s66, s66, 155136
  v_add_u32 v101, s66, v101
  v_add_u32 v102, 0, v100
  v_subrev_u32 v103, 24, v102
  v_min_u32 v102, v102, v103
  v_lshl_add_u32 v102, v102, 6, v101
  v_accvgpr_write_b32 a24, v102
  v_add_u32 v102, 4, v100
  v_subrev_u32 v103, 24, v102
  v_min_u32_e64 v102, v102, v103
  v_lshl_add_u32 v102, v102, 6, v101
  v_accvgpr_write_b32 a25, v102
  v_add_u32 v102, 8, v100
  v_subrev_u32 v103, 24, v102
  v_min_u32_e64 v102, v102, v103
  v_lshl_add_u32 v102, v102, 6, v101
  v_accvgpr_write_b32 a26, v102
  v_add_u32 v102, 12, v100
  v_subrev_u32 v103, 24, v102
  v_min_u32_e64 v102, v102, v103
  v_lshl_add_u32 v102, v102, 6, v101
  v_accvgpr_write_b32 a27, v102
  v_add_u32 v102, 16, v100
  v_subrev_u32 v103, 24, v102
  v_min_u32_e64 v102, v102, v103
  v_lshl_add_u32 v102, v102, 6, v101
  v_accvgpr_write_b32 a28, v102
  v_add_u32 v102, 20, v100
  v_subrev_u32 v103, 24, v102
  v_min_u32_e64 v102, v102, v103
  v_lshl_add_u32 v102, v102, 6, v101
  v_accvgpr_write_b32 a29, v102
  v_lshlrev_b32_e64 v100, 2, v0
  v_add_u32 v100, 155136, v100
  v_accvgpr_write_b32 a30, v100
  v_lshlrev_b32 v101, 12, v0
  s_lshl_b32 s66, s2, 4
  s_add_u32 s66, s66, 4096
  v_add_u32_e64 v101, s66, v101
  v_accvgpr_write_b32 a31, v101
  s_waitcnt lgkmcnt(0)
  s_waitcnt vmcnt(8)
  s_barrier
  s_nop 0
  ds_read_u16 v100, v240 offset:0
  ds_read_u16 v101, v240 offset:192
  ds_read_u16 v102, v240 offset:1920
  ds_read_u16 v103, v240 offset:2112
  ds_read_u16 v104, v240 offset:3840
  ds_read_u16 v105, v240 offset:4032
  ds_read_u16 v106, v241 offset:0
  ds_read_u16 v107, v241 offset:960
  s_add_u32 m0, s65, 30720
  s_add_u32 s67, s48, 344064
  buffer_load_dwordx4 v10, s[24:27], s67 offen nt lds
  ds_read_u16 v108, v240 offset:16
  ds_read_u16 v109, v240 offset:208
  ds_read_u16 v110, v240 offset:1936
  ds_read_u16 v111, v240 offset:2128
  ds_read_u16 v112, v240 offset:3856
  ds_read_u16 v113, v240 offset:4048
  ds_read_u16 v114, v241 offset:16
  s_waitcnt lgkmcnt(13)
  s_nop 0
  ds_read_u16 v115, v241 offset:976
  s_add_u32 m0, s65, 34560
  s_add_u32 s67, s48, 387072
  buffer_load_dwordx4 v10, s[24:27], s67 offen nt lds
  s_waitcnt lgkmcnt(8)
  v_and_b32 v44, v100, v242
  v_and_b32 v45, v100, v243
  v_and_b32 v46, v101, v242
  v_and_b32 v47, v101, v243
  v_and_b32 v48, v102, v242
  v_and_b32 v49, v102, v243
  v_and_b32 v50, v103, v242
  v_and_b32 v51, v103, v243
  v_and_b32 v52, v104, v242
  v_and_b32 v53, v104, v243
  v_and_b32 v54, v105, v242
  v_and_b32 v55, v105, v243
  v_and_b32 v56, v106, v242
  v_and_b32 v57, v106, v243
  v_and_b32 v58, v107, v242
  v_and_b32_e64 v59, v107, v243
  s_add_u32 m0, s65, 38400
  s_add_u32 s67, s48, 430080
  buffer_load_dwordx4 v10, s[24:27], s67 offen nt lds
  ds_read_u16 v116, v240 offset:32
  ds_read_u16 v117, v240 offset:224
  ds_read_u16 v118, v240 offset:1952
  ds_read_u16 v119, v240 offset:2144
  ds_read_u16 v120, v240 offset:3872
  ds_read_u16 v121, v240 offset:4064
  ds_read_u16 v122, v241 offset:32
  s_waitcnt lgkmcnt(13)
  s_nop 0
  ds_read_u16 v123, v241 offset:992
  s_add_u32 m0, s65, 42240
  s_add_u32 s67, s48, 473088
  buffer_load_dwordx4 v10, s[24:27], s67 offen nt lds
  s_waitcnt lgkmcnt(8)
  v_and_b32 v60, v108, v242
  v_and_b32 v61, v108, v243
  v_and_b32 v62, v109, v242
  v_and_b32 v63, v109, v243
  v_and_b32 v64, v110, v242
  v_and_b32 v65, v110, v243
  v_and_b32 v66, v111, v242
  v_and_b32 v67, v111, v243
  v_and_b32 v68, v112, v242
  v_and_b32 v69, v112, v243
  v_and_b32 v70, v113, v242
  v_and_b32 v71, v113, v243
  v_and_b32 v72, v114, v242
  v_and_b32 v73, v114, v243
  v_and_b32 v74, v115, v242
  v_and_b32 v75, v115, v243
  s_waitcnt lgkmcnt(0)
  v_and_b32 v76, v116, v242
  v_and_b32 v77, v116, v243
  v_and_b32 v78, v117, v242
  v_and_b32 v79, v117, v243
  v_and_b32 v80, v118, v242
  v_and_b32 v81, v118, v243
  v_and_b32 v82, v119, v242
  v_and_b32 v83, v119, v243
  v_and_b32 v84, v120, v242
  v_and_b32 v85, v120, v243
  v_and_b32 v86, v121, v242
  v_and_b32 v87, v121, v243
  v_and_b32 v88, v122, v242
  v_and_b32 v89, v122, v243
  v_and_b32 v90, v123, v242
  v_and_b32 v91, v123, v243
  s_waitcnt vmcnt(6)
  s_barrier
  ds_read_b128 a[100:103], v93 offset:0
  ds_read_b128 a[104:107], v93 offset:3840
  ds_read_b128 a[124:127], v93 offset:7680
  ds_read_b128 a[128:131], v93 offset:11520
  ds_read_b128 a[148:151], v93 offset:15360
  ds_read_b128 a[152:155], v93 offset:19200
  ds_read_b128 a[196:199], v94 offset:0
  ds_read_b128 a[200:203], v95 offset:0
  v_mov_b64 v[208:209], 0
  v_mov_b64 v[210:211], 0
  v_mov_b64 v[212:213], 0
  v_mov_b64 v[214:215], 0
  v_mov_b64 v[216:217], 0
  v_mov_b64 v[218:219], 0
  ds_read_b128 a[108:111], v93 offset:16
  ds_read_b128 a[112:115], v93 offset:3856
  ds_read_b128 a[132:135], v93 offset:7696
  ds_read_b128 a[136:139], v93 offset:11536
  ds_read_b128 a[156:159], v93 offset:15376
  ds_read_b128 a[160:163], v93 offset:19216
  ds_read_b128 a[204:207], v94 offset:16
  s_waitcnt lgkmcnt(13)
  ds_read_b128 a[208:211], v95 offset:16
  ds_read_b128 a[116:119], v93 offset:32
  s_waitcnt lgkmcnt(13)
  ds_read_b128 a[120:123], v93 offset:3872
  ds_read_b128 a[140:143], v93 offset:7712
  s_waitcnt lgkmcnt(13)
  ds_read_b128 a[144:147], v93 offset:11552
  ds_read_b128 a[164:167], v93 offset:15392
  s_waitcnt lgkmcnt(13)
  ds_read_b128 a[168:171], v93 offset:19232
  ds_read_b128 a[212:215], v94 offset:32
  s_waitcnt lgkmcnt(13)
  ds_read_b128 a[216:219], v95 offset:32
  s_waitcnt vmcnt(4)
  s_barrier
  s_waitcnt lgkmcnt(0)
  s_mul_i32 s66, s44, 208
  s_add_u32 s66, s66, 92576
  v_lshrrev_b32_e64 v205, 2, v1
  v_min_u32 v205, 188, v205
  v_add_u32_e64 v205, s66, v205
  ds_read_b32 a99, v205
  ds_read_b128 a[32:35], v238 offset:0
  ds_read_b128 a[36:39], v238 offset:64
  ds_read_b128 a[40:43], v238 offset:128
  v_smfmac_f32_16x16x64_bf16 v[208:211], v[44:47], a[100:107], v92
  ds_read_b128 a[172:175], v93 offset:23040
  v_mov_b64_e64 v[220:221], 0
  v_smfmac_f32_16x16x64_bf16 v[212:215], v[60:63], a[108:115], v92
  ds_read_b128 a[176:179], v93 offset:26880
  v_mov_b64_e64 v[222:223], 0
  v_smfmac_f32_16x16x64_bf16 v[216:219], v[76:79], a[116:123], v92
  ds_read_b128 a[220:223], v94 offset:7680
  v_mov_b64_e64 v[224:225], 0
  s_add_u32 m0, s65, 46080
  s_add_u32 s67, s48, 516096
  buffer_load_dwordx4 v10, s[24:27], s67 offen nt lds
  v_smfmac_f32_16x16x64_bf16 v[208:211], v[48:51], a[124:131], v92
  ds_read_b128 a[224:227], v95 offset:7680
  v_mov_b64_e64 v[226:227], 0
  v_smfmac_f32_16x16x64_bf16 v[212:215], v[64:67], a[132:139], v92
  ds_read_b128 a[180:183], v93 offset:23056
  v_mov_b64_e64 v[228:229], 0
  v_smfmac_f32_16x16x64_bf16 v[216:219], v[80:83], a[140:147], v92
  ds_read_b128 a[184:187], v93 offset:26896
  v_mov_b64_e64 v[230:231], 0
  v_smfmac_f32_16x16x64_bf16 v[208:211], v[52:55], a[148:155], v92
  ds_read_b128 a[228:231], v94 offset:7696
  s_add_u32 m0, s65, 49920
  s_add_u32 s67, s48, 559104
  buffer_load_dwordx4 v10, s[24:27], s67 offen nt lds
  v_smfmac_f32_16x16x64_bf16 v[212:215], v[68:71], a[156:163], v92
  ds_read_b128 a[232:235], v95 offset:7696
  v_smfmac_f32_16x16x64_bf16 v[216:219], v[84:87], a[164:171], v92
  ds_read_b128 a[188:191], v93 offset:23072
  v_smfmac_f32_16x16x64_bf16 v[208:211], v[56:59], a[196:203], v92
  ds_read_b128 a[192:195], v93 offset:26912
  v_smfmac_f32_16x16x64_bf16 v[212:215], v[72:75], a[204:211], v92
  ds_read_b128 a[236:239], v94 offset:7712
  s_add_u32 m0, s65, 53760
  s_add_u32 s67, s48, 602112
  buffer_load_dwordx4 v10, s[24:27], s67 offen nt lds
  v_smfmac_f32_16x16x64_bf16 v[216:219], v[88:91], a[212:219], v92
  s_waitcnt lgkmcnt(13)
  ds_read_b128 a[240:243], v95 offset:7712
  s_nop 4
  v_cvt_pk_bf16_f32 v232, v208, v209
  v_cvt_pk_bf16_f32 v233, v210, v211
  ds_write_b64 v96, v[232:233] offset:0
  v_cvt_pk_bf16_f32 v234, v212, v213
  v_cvt_pk_bf16_f32 v235, v214, v215
  s_waitcnt lgkmcnt(13)
  s_nop 0
  ds_write_b64 v96, v[234:235] offset:16
  v_cvt_pk_bf16_f32 v236, v216, v217
  v_cvt_pk_bf16_f32 v237, v218, v219
  ds_write_b64 v96, v[236:237] offset:32
  s_waitcnt lgkmcnt(0)
  s_barrier
  ds_read_b64 v[192:193], v97 offset:0
  ds_read_b64 v[194:195], v97 offset:32
  ds_read_b64 v[196:197], v97 offset:64
  ds_read_b64 v[198:199], v97 offset:96
  ds_read_b64 v[200:201], v97 offset:128
  ds_read_b64 v[202:203], v97 offset:160
  s_waitcnt lgkmcnt(0)
  s_nop 0
  v_mfma_f32_16x16x32_bf16 v[124:127], v[192:195], v[192:195], 0
  v_mfma_f32_16x16x32_bf16 v[128:131], a[92:95], v[192:195], 0
  v_mfma_f32_16x16x32_bf16 v[124:127], v[196:199], v[196:199], v[124:127]
  v_mfma_f32_16x16x32_bf16 v[128:131], a[92:95], v[196:199], v[128:131]
  v_mfma_f32_16x16x32_bf16 v[124:127], v[200:203], v[200:203], v[124:127]
  v_mfma_f32_16x16x32_bf16 v[128:131], a[92:95], v[200:203], v[128:131]
  v_mfma_f32_16x16x32_bf16 v[100:103], a[84:87], v[192:195], 0
  v_mfma_f32_16x16x32_bf16 v[104:107], a[88:91], v[192:195], 0
  s_nop 4
  s_nop 0
  v_cndmask_b32 v132, v124, v125, s[54:55]
  v_mfma_f32_16x16x32_bf16 v[108:111], a[84:87], v[196:199], 0
  v_cndmask_b32 v132, v132, v126, s[56:57]
  v_mfma_f32_16x16x32_bf16 v[112:115], a[88:91], v[196:199], 0
  v_cndmask_b32 v132, v132, v127, s[58:59]
  v_mfma_f32_16x16x32_bf16 v[116:119], a[84:87], v[200:203], 0
  v_cndmask_b32 v132, 0, v132, s[60:61]
  v_mfma_f32_16x16x32_bf16 v[120:123], a[88:91], v[200:203], 0
  v_mov_b32_e64 v133, 1.0
  v_mul_f32 v134, 0x3c2aaaab, v128
  s_nop 0
  v_mfma_f32_16x16x4_f32 v[124:127], v133, v132, 0
  s_nop 9
  v_mul_f32 v135, 0x3c2aaaab, v124
  v_fma_f32 v135, -v134, v134, v135
  v_max_f32_e64 v135, 0, v135
  v_add_f32 v135, 0x3727c5ac, v135
  v_rsq_f32_e64 v135, v135
  v_mul_f32 v134, 0x3eeff558, v134
  v_mul_f32 v136, 0xbeeff558, v135
  v_cndmask_b32 v136, 0, v136, s[62:63]
  v_mul_f32_e64 v132, v134, v135
  v_cndmask_b32 v132, 0, v132, s[62:63]
  v_pk_fma_f32 v[100:101], v[100:101], v[136:137], v[132:133] op_sel_hi:[1,0,0]
  v_pk_fma_f32 v[102:103], v[102:103], v[136:137], v[132:133] op_sel_hi:[1,0,0]
  v_pk_fma_f32 v[104:105], v[104:105], v[136:137], v[132:133] op_sel_hi:[1,0,0]
  v_pk_fma_f32 v[106:107], v[106:107], v[136:137], v[132:133] op_sel_hi:[1,0,0]
  v_pk_fma_f32 v[108:109], v[108:109], v[136:137], v[132:133] op_sel_hi:[1,0,0]
  v_pk_fma_f32 v[110:111], v[110:111], v[136:137], v[132:133] op_sel_hi:[1,0,0]
  v_pk_fma_f32 v[112:113], v[112:113], v[136:137], v[132:133] op_sel_hi:[1,0,0]
  v_pk_fma_f32 v[114:115], v[114:115], v[136:137], v[132:133] op_sel_hi:[1,0,0]
  v_pk_fma_f32 v[116:117], v[116:117], v[136:137], v[132:133] op_sel_hi:[1,0,0]
  v_pk_fma_f32 v[118:119], v[118:119], v[136:137], v[132:133] op_sel_hi:[1,0,0]
  v_pk_fma_f32 v[120:121], v[120:121], v[136:137], v[132:133] op_sel_hi:[1,0,0]
  v_pk_fma_f32 v[122:123], v[122:123], v[136:137], v[132:133] op_sel_hi:[1,0,0]
  v_cvt_pk_bf16_f32 v140, v100, v101
  v_cvt_pk_bf16_f32 v141, v102, v103
  v_cvt_pk_bf16_f32 v142, v104, v105
  v_cvt_pk_bf16_f32 v143, v106, v107
  v_cvt_pk_bf16_f32 v144, v108, v109
  v_cvt_pk_bf16_f32 v145, v110, v111
  v_cvt_pk_bf16_f32 v146, v112, v113
  v_cvt_pk_bf16_f32 v147, v114, v115
  v_cvt_pk_bf16_f32 v188, v116, v117
  v_cvt_pk_bf16_f32 v189, v118, v119
  v_cvt_pk_bf16_f32 v190, v120, v121
  v_cvt_pk_bf16_f32 v191, v122, v123
  s_waitcnt lgkmcnt(6)
  s_waitcnt vmcnt(5)
  s_barrier
  s_waitcnt lgkmcnt(9)
  v_smfmac_f32_16x16x64_bf16 v[220:223], v[44:47], a[124:131], v92
  ds_read_b128 a[100:103], v93 offset:30720
  v_smfmac_f32_16x16x64_bf16 v[224:227], v[60:63], a[132:139], v92
  ds_read_b128 a[104:107], v93 offset:34560
  v_mov_b64_e64 v[208:209], 0
  v_smfmac_f32_16x16x64_bf16 v[228:231], v[76:79], a[140:147], v92
  ds_read_b128 a[196:199], v94 offset:15360
  v_mov_b64_e64 v[210:211], 0
  s_add_u32 m0, s65, 57600
  s_add_u32 s67, s48, 645120
  buffer_load_dwordx4 v10, s[24:27], s67 offen nt lds
  v_smfmac_f32_16x16x64_bf16 v[220:223], v[48:51], a[148:155], v92
  ds_read_b128 a[200:203], v95 offset:15360
  v_mov_b64_e64 v[212:213], 0
  v_smfmac_f32_16x16x64_bf16 v[224:227], v[64:67], a[156:163], v92
  ds_read_b128 a[108:111], v93 offset:30736
  v_mov_b64_e64 v[214:215], 0
  v_smfmac_f32_16x16x64_bf16 v[228:231], v[80:83], a[164:171], v92
  ds_read_b128 a[112:115], v93 offset:34576
  v_mov_b64_e64 v[216:217], 0
  v_smfmac_f32_16x16x64_bf16 v[220:223], v[52:55], a[172:179], v92
  ds_read_b128 a[204:207], v94 offset:15376
  v_mov_b64_e64 v[218:219], 0
  s_add_u32 s67, s48, 688128
  s_cmp_eq_u32 s46, 210
  s_cselect_b32 s67, s64, s67
  s_add_u32 m0, s65, 61440
  s_nop 0
  buffer_load_dwordx4 v10, s[24:27], s67 offen nt lds
  v_smfmac_f32_16x16x64_bf16 v[224:227], v[68:71], a[180:187], v92
  ds_read_b128 a[208:211], v95 offset:15376
  v_smfmac_f32_16x16x64_bf16 v[228:231], v[84:87], a[188:195], v92
  ds_read_b128 a[116:119], v93 offset:30752
  v_smfmac_f32_16x16x64_bf16 v[220:223], v[56:59], a[220:227], v92
  ds_read_b128 a[120:123], v93 offset:34592
  v_smfmac_f32_16x16x64_bf16 v[224:227], v[72:75], a[228:235], v92
  ds_read_b128 a[212:215], v94 offset:15392
  s_add_u32 s67, s48, 731136
  s_cmp_eq_u32 s46, 210
  s_cselect_b32 s67, s64, s67
  s_add_u32 m0, s65, 65280
  s_nop 0
  buffer_load_dwordx4 v10, s[24:27], s67 offen nt lds
  v_smfmac_f32_16x16x64_bf16 v[228:231], v[88:91], a[236:243], v92
  ds_read_b128 a[216:219], v95 offset:15392
  s_waitcnt vmcnt(6)
  s_barrier
  s_waitcnt lgkmcnt(0)
  s_nop 0
  ds_read_b128 a[44:47], v239 offset:0
  ds_read_b128 a[48:51], v239 offset:64
  ds_read_b128 a[52:55], v239 offset:128
  v_smfmac_f32_16x16x64_bf16 v[208:211], v[44:47], a[148:155], v92
  ds_read_b128 a[124:127], v93 offset:38400
  v_smfmac_f32_16x16x64_bf16 v[212:215], v[60:63], a[156:163], v92
  ds_read_b128 a[128:131], v93 offset:42240
  v_cvt_pk_bf16_f32 v232, v220, v221
  v_smfmac_f32_16x16x64_bf16 v[216:219], v[76:79], a[164:171], v92
  ds_read_b128 a[220:223], v94 offset:23040
  v_cvt_pk_bf16_f32 v233, v222, v223
  s_getpc_b64 s[68:69]
L_pcrefb:
  s_sub_u32 s68, s68, L_pcrefb-standalone__modern_conv_block_slak__vision_kernel
  s_subb_u32 s69, s69, 0
  s_lshr_b32 s66, s2, 3
  s_lshl_b32 s66, s66, 2
  s_add_u32 s66, s66, s44
  s_sub_u32 s66, s66, 64
  s_cbranch_scc1 L_notouchb
  s_add_u32 s66, s66, 16
  s_lshl_b32 s66, s66, 10
  s_cmp_ge_u32 s66, L_end-standalone__modern_conv_block_slak__vision_kernel
  s_cbranch_scc1 L_notouchb
  s_min_u32 s66, s66, L_end-standalone__modern_conv_block_slak__vision_kernel-1020
  v_add_u32 v20, s66, v1
  v_mov_b32 v23, s69
  v_add_co_u32 v22, vcc, s68, v20
  s_nop 1
  v_addc_co_u32_e64 v23, vcc, 0, v23, vcc
  global_load_dwordx4 a[252:255], v[22:23], off
L_notouchb:
  v_smfmac_f32_16x16x64_bf16 v[208:211], v[48:51], a[172:179], v92
  ds_read_b128 a[224:227], v95 offset:23040
  v_cvt_pk_bf16_f32 v234, v224, v225
  ds_write_b64 v96, v[232:233] offset:7680
  v_smfmac_f32_16x16x64_bf16 v[212:215], v[64:67], a[180:187], v92
  ds_read_b128 a[132:135], v93 offset:38416
  v_cvt_pk_bf16_f32 v235, v226, v227
  v_smfmac_f32_16x16x64_bf16 v[216:219], v[80:83], a[188:195], v92
  ds_read_b128 a[136:139], v93 offset:42256
  v_cvt_pk_bf16_f32 v236, v228, v229
  ds_write_b64 v96, v[234:235] offset:7696
  v_smfmac_f32_16x16x64_bf16 v[208:211], v[52:55], a[100:107], v92
  ds_read_b128 a[228:231], v94 offset:23056
  v_cvt_pk_bf16_f32 v237, v230, v231
  s_add_u32 m0, s76, 0
  s_add_u32 s66, s77, 0
  buffer_load_dwordx4 v7, s[32:35], s66 offen lds
  v_smfmac_f32_16x16x64_bf16 v[212:215], v[68:71], a[108:115], v92
  ds_read_b128 a[232:235], v95 offset:23056
  v_mov_b64_e64 v[220:221], 0
  ds_write_b64 v96, v[236:237] offset:7712
  v_smfmac_f32_16x16x64_bf16 v[216:219], v[84:87], a[116:123], v92
  ds_read_b128 a[140:143], v93 offset:38432
  v_mov_b64_e64 v[222:223], 0
  v_smfmac_f32_16x16x64_bf16 v[208:211], v[56:59], a[196:203], v92
  s_waitcnt lgkmcnt(13)
  ds_read_b128 a[144:147], v93 offset:42272
  v_mov_b64 v[224:225], 0
  v_smfmac_f32_16x16x64_bf16 v[212:215], v[72:75], a[204:211], v92
  ds_read_b128 a[236:239], v94 offset:23072
  v_mov_b64 v[226:227], 0
  s_cmp_eq_u32 s44, 1
  s_cselect_b32 s72, s14, s12
  s_cselect_b32 s73, s15, s13
  s_mul_i32 s68, s44, 768
  s_add_u32 s68, s68, 153600
  s_and_b32 s73, s73, 0xffff
  s_mov_b32 s74, 768
  s_mov_b32 s75, 0x20000
  s_mov_b32 m0, s68
  s_cmp_lt_u32 s44, 2
  s_cbranch_scc0 L_nogb
  s_mov_b32 exec_hi, 0xffff
  buffer_load_dwordx4 v1, s[72:75], 0 offen lds
  s_mov_b32 exec_hi, -1
L_nogb:
  v_smfmac_f32_16x16x64_bf16 v[216:219], v[88:91], a[212:219], v92
  s_waitcnt lgkmcnt(13)
  ds_read_b128 a[240:243], v95 offset:23072
  v_mov_b64 v[228:229], 0
  v_mov_b64 v[230:231], 0
  s_waitcnt vmcnt(5)
  s_barrier
  s_waitcnt lgkmcnt(0)
  v_smfmac_f32_16x16x64_bf16 v[220:223], v[44:47], a[172:179], v92
  ds_read_b128 a[148:151], v93 offset:46080
  v_smfmac_f32_16x16x64_bf16 v[224:227], v[60:63], a[180:187], v92
  ds_read_b128 a[152:155], v93 offset:49920
  v_cvt_pk_bf16_f32 v232, v208, v209
  v_smfmac_f32_16x16x64_bf16 v[228:231], v[76:79], a[188:195], v92
  ds_read_b128 a[196:199], v94 offset:30720
  v_cvt_pk_bf16_f32 v233, v210, v211
  s_add_u32 m0, s76, 800
  s_add_u32 s66, s77, 768
  buffer_load_dwordx4 v7, s[32:35], s66 offen lds
  v_smfmac_f32_16x16x64_bf16 v[220:223], v[48:51], a[100:107], v92
  ds_read_b128 a[200:203], v95 offset:30720
  v_cvt_pk_bf16_f32 v234, v212, v213
  ds_write_b64 v96, v[232:233] offset:15360
  v_smfmac_f32_16x16x64_bf16 v[224:227], v[64:67], a[108:115], v92
  ds_read_b128 a[156:159], v93 offset:46096
  v_cvt_pk_bf16_f32 v235, v214, v215
  v_smfmac_f32_16x16x64_bf16 v[228:231], v[80:83], a[116:123], v92
  ds_read_b128 a[160:163], v93 offset:49936
  v_cvt_pk_bf16_f32 v236, v216, v217
  ds_write_b64 v96, v[234:235] offset:15376
  v_smfmac_f32_16x16x64_bf16 v[220:223], v[52:55], a[124:131], v92
  ds_read_b128 a[204:207], v94 offset:30736
  v_cvt_pk_bf16_f32 v237, v218, v219
  s_add_u32 m0, s76, 1600
  s_add_u32 s66, s77, 1536
  buffer_load_dwordx4 v7, s[32:35], s66 offen lds
  v_smfmac_f32_16x16x64_bf16 v[224:227], v[68:71], a[132:139], v92
  ds_read_b128 a[208:211], v95 offset:30736
  v_mov_b64_e64 v[208:209], 0
  ds_write_b64 v96, v[236:237] offset:15392
  v_smfmac_f32_16x16x64_bf16 v[228:231], v[84:87], a[140:147], v92
  ds_read_b128 a[164:167], v93 offset:46112
  v_mov_b64_e64 v[210:211], 0
  v_smfmac_f32_16x16x64_bf16 v[220:223], v[56:59], a[220:227], v92
  ds_read_b128 a[168:171], v93 offset:49952
  v_mov_b64_e64 v[212:213], 0
  v_smfmac_f32_16x16x64_bf16 v[224:227], v[72:75], a[228:235], v92
  ds_read_b128 a[212:215], v94 offset:30752
  v_mov_b64_e64 v[214:215], 0
  s_add_u32 m0, s76, 2400
  s_add_u32 s66, s77, 2304
  buffer_load_dwordx4 v7, s[32:35], s66 offen lds
  v_smfmac_f32_16x16x64_bf16 v[228:231], v[88:91], a[236:243], v92
  ds_read_b128 a[216:219], v95 offset:30752
  v_mov_b64 v[216:217], 0
  v_mov_b64_e64 v[218:219], 0
  s_waitcnt vmcnt(6)
  s_barrier
  s_waitcnt lgkmcnt(0)
  ds_read_b128 a[56:59], v204 offset:0
  ds_read_b128 a[60:63], v204 offset:64
  ds_read_b128 a[64:67], v204 offset:128
  v_smfmac_f32_16x16x64_bf16 v[208:211], v[44:47], a[100:107], v92
  ds_read_b128 a[172:175], v93 offset:53760
  v_smfmac_f32_16x16x64_bf16 v[212:215], v[60:63], a[108:115], v92
  ds_read_b128 a[176:179], v93 offset:57600
  v_cvt_pk_bf16_f32 v232, v220, v221
  v_smfmac_f32_16x16x64_bf16 v[216:219], v[76:79], a[116:123], v92
  ds_read_b128 a[220:223], v94 offset:38400
  v_cvt_pk_bf16_f32 v233, v222, v223
  s_add_u32 m0, s76, 3200
  s_add_u32 s66, s77, 3072
  buffer_load_dwordx4 v7, s[32:35], s66 offen lds
  v_smfmac_f32_16x16x64_bf16 v[208:211], v[48:51], a[124:131], v92
  ds_read_b128 a[224:227], v95 offset:38400
  v_cvt_pk_bf16_f32 v234, v224, v225
  ds_write_b64 v96, v[232:233] offset:23040
  v_smfmac_f32_16x16x64_bf16 v[212:215], v[64:67], a[132:139], v92
  ds_read_b128 a[180:183], v93 offset:53776
  v_cvt_pk_bf16_f32 v235, v226, v227
  v_smfmac_f32_16x16x64_bf16 v[216:219], v[80:83], a[140:147], v92
  ds_read_b128 a[184:187], v93 offset:57616
  v_cvt_pk_bf16_f32 v236, v228, v229
  ds_write_b64 v96, v[234:235] offset:23056
  v_smfmac_f32_16x16x64_bf16 v[208:211], v[52:55], a[148:155], v92
  ds_read_b128 a[228:231], v94 offset:38416
  v_cvt_pk_bf16_f32 v237, v230, v231
  s_lshr_b32 s66, s2, 3
  s_lshl_b32 s66, s66, 2
  s_add_u32 s66, s66, s44
  s_lshl_b32 s66, s66, 10
  buffer_load_dwordx4 a[244:247], v1, s[36:39], s66 offen
  v_smfmac_f32_16x16x64_bf16 v[212:215], v[68:71], a[156:163], v92
  ds_read_b128 a[232:235], v95 offset:38416
  v_mov_b64_e64 v[220:221], 0
  ds_write_b64 v96, v[236:237] offset:23072
  v_smfmac_f32_16x16x64_bf16 v[216:219], v[84:87], a[164:171], v92
  ds_read_b128 a[188:191], v93 offset:53792
  v_mov_b64_e64 v[222:223], 0
  v_smfmac_f32_16x16x64_bf16 v[208:211], v[56:59], a[196:203], v92
  s_waitcnt lgkmcnt(13)
  ds_read_b128 a[192:195], v93 offset:57632
  v_mov_b64 v[224:225], 0
  v_smfmac_f32_16x16x64_bf16 v[212:215], v[72:75], a[204:211], v92
  ds_read_b128 a[236:239], v94 offset:38432
  v_mov_b64_e64 v[226:227], 0
  s_add_u32 m0, s76, 4000
  s_add_u32 s66, s77, 3840
  buffer_load_dwordx4 v7, s[32:35], s66 offen lds
  v_smfmac_f32_16x16x64_bf16 v[216:219], v[88:91], a[212:219], v92
  s_waitcnt lgkmcnt(13)
  ds_read_b128 a[240:243], v95 offset:38432
  v_mov_b64 v[228:229], 0
  v_mov_b64 v[230:231], 0
  s_waitcnt vmcnt(7)
  s_barrier
  s_waitcnt lgkmcnt(0)
  v_smfmac_f32_16x16x64_bf16 v[220:223], v[44:47], a[124:131], v92
  ds_read_b128 a[100:103], v93 offset:61440
  v_smfmac_f32_16x16x64_bf16 v[224:227], v[60:63], a[132:139], v92
  ds_read_b128 a[104:107], v93 offset:65280
  v_cvt_pk_bf16_f32 v232, v208, v209
  v_smfmac_f32_16x16x64_bf16 v[228:231], v[76:79], a[140:147], v92
  ds_read_b128 a[196:199], v94 offset:46080
  v_cvt_pk_bf16_f32 v233, v210, v211
  s_add_u32 m0, s76, 4800
  s_add_u32 s66, s77, 4608
  buffer_load_dwordx4 v7, s[32:35], s66 offen lds
  v_smfmac_f32_16x16x64_bf16 v[220:223], v[48:51], a[148:155], v92
  ds_read_b128 a[200:203], v95 offset:46080
  v_cvt_pk_bf16_f32 v234, v212, v213
  ds_write_b64 v96, v[232:233] offset:30720
  v_smfmac_f32_16x16x64_bf16 v[224:227], v[64:67], a[156:163], v92
  ds_read_b128 a[108:111], v93 offset:61456
  v_cvt_pk_bf16_f32 v235, v214, v215
  v_smfmac_f32_16x16x64_bf16 v[228:231], v[80:83], a[164:171], v92
  ds_read_b128 a[112:115], v93 offset:65296
  v_cvt_pk_bf16_f32 v236, v216, v217
  ds_write_b64 v96, v[234:235] offset:30736
  v_smfmac_f32_16x16x64_bf16 v[220:223], v[52:55], a[172:179], v92
  ds_read_b128 a[204:207], v94 offset:46096
  v_cvt_pk_bf16_f32 v237, v218, v219
  s_add_u32 m0, s76, 5600
  s_add_u32 s66, s77, 5376
  buffer_load_dwordx4 v7, s[32:35], s66 offen lds
  v_smfmac_f32_16x16x64_bf16 v[224:227], v[68:71], a[180:187], v92
  ds_read_b128 a[208:211], v95 offset:46096
  v_mov_b64_e64 v[208:209], 0
  ds_write_b64 v96, v[236:237] offset:30752
  v_smfmac_f32_16x16x64_bf16 v[228:231], v[84:87], a[188:195], v92
  ds_read_b128 a[116:119], v93 offset:61472
  v_mov_b64_e64 v[210:211], 0
  v_smfmac_f32_16x16x64_bf16 v[220:223], v[56:59], a[220:227], v92
  ds_read_b128 a[120:123], v93 offset:65312
  v_mov_b64_e64 v[212:213], 0
  v_smfmac_f32_16x16x64_bf16 v[224:227], v[72:75], a[228:235], v92
  ds_read_b128 a[212:215], v94 offset:46112
  v_mov_b64_e64 v[214:215], 0
  s_add_u32 m0, s76, 6400
  s_add_u32 s66, s77, 6144
  buffer_load_dwordx4 v7, s[32:35], s66 offen lds
  v_smfmac_f32_16x16x64_bf16 v[228:231], v[88:91], a[236:243], v92
  ds_read_b128 a[216:219], v95 offset:46112
  v_mov_b64 v[216:217], 0
  v_mov_b64_e64 v[218:219], 0
  s_waitcnt lgkmcnt(13)
  ds_read_b64 v[192:193], v98 offset:0
  ds_read_b64 v[194:195], v98 offset:32
  s_waitcnt lgkmcnt(13)
  ds_read_b64 v[196:197], v98 offset:64
  ds_read_b64 v[198:199], v98 offset:96
  s_waitcnt lgkmcnt(13)
  ds_read_b64 v[200:201], v98 offset:128
  ds_read_b64 v[202:203], v98 offset:160
  s_waitcnt lgkmcnt(0)
  s_nop 0
  v_mfma_f32_16x16x32_bf16 v[124:127], v[192:195], v[192:195], 0
  v_mfma_f32_16x16x32_bf16 v[128:131], a[92:95], v[192:195], 0
  v_mfma_f32_16x16x32_bf16 v[124:127], v[196:199], v[196:199], v[124:127]
  v_mfma_f32_16x16x32_bf16 v[128:131], a[92:95], v[196:199], v[128:131]
  v_mfma_f32_16x16x32_bf16 v[124:127], v[200:203], v[200:203], v[124:127]
  v_mfma_f32_16x16x32_bf16 v[128:131], a[92:95], v[200:203], v[128:131]
  s_add_u32 m0, s76, 7200
  s_add_u32 s66, s77, 6912
  buffer_load_dwordx4 v7, s[32:35], s66 offen lds
  v_mfma_f32_16x16x32_bf16 v[100:103], a[84:87], v[192:195], 0
  v_mfma_f32_16x16x32_bf16 v[104:107], a[88:91], v[192:195], 0
  s_nop 1
  s_nop 0
  v_cndmask_b32 v132, v124, v125, s[54:55]
  v_mfma_f32_16x16x32_bf16 v[108:111], a[84:87], v[196:199], 0
  v_cndmask_b32 v132, v132, v126, s[56:57]
  v_mfma_f32_16x16x32_bf16 v[112:115], a[88:91], v[196:199], 0
  v_cndmask_b32 v132, v132, v127, s[58:59]
  v_mfma_f32_16x16x32_bf16 v[116:119], a[84:87], v[200:203], 0
  v_cndmask_b32 v132, 0, v132, s[60:61]
  v_mfma_f32_16x16x32_bf16 v[120:123], a[88:91], v[200:203], 0
  v_mov_b32_e64 v133, 1.0
  v_mul_f32 v134, 0x3c2aaaab, v128
  s_add_u32 m0, s76, 8000
  s_add_u32 s66, s77, 7680
  buffer_load_dwordx4 v7, s[32:35], s66 offen lds
  v_mfma_f32_16x16x4_f32 v[124:127], v133, v132, 0
  s_add_u32 m0, s76, 8800
  s_add_u32 s66, s77, 8448
  buffer_load_dwordx4 v7, s[32:35], s66 offen lds
  s_nop 6
  v_mul_f32 v135, 0x3c2aaaab, v124
  v_fma_f32 v135, -v134, v134, v135
  v_max_f32 v135, 0, v135
  v_add_f32 v135, 0x3727c5ac, v135
  v_rsq_f32_e64 v135, v135
  v_mul_f32 v134, 0x3eeff558, v134
  v_mul_f32 v136, 0xbeeff558, v135
  v_mul_f32_e64 v132, v134, v135
  s_add_u32 m0, s76, 9600
  s_add_u32 s66, s77, 9216
  buffer_load_dwordx4 v7, s[32:35], s66 offen lds
  v_pk_fma_f32 v[100:101], v[100:101], v[136:137], v[132:133] op_sel_hi:[1,0,0]
  v_pk_fma_f32 v[102:103], v[102:103], v[136:137], v[132:133] op_sel_hi:[1,0,0]
  v_pk_fma_f32 v[104:105], v[104:105], v[136:137], v[132:133] op_sel_hi:[1,0,0]
  v_pk_fma_f32 v[106:107], v[106:107], v[136:137], v[132:133] op_sel_hi:[1,0,0]
  v_pk_fma_f32 v[108:109], v[108:109], v[136:137], v[132:133] op_sel_hi:[1,0,0]
  v_pk_fma_f32 v[110:111], v[110:111], v[136:137], v[132:133] op_sel_hi:[1,0,0]
  v_pk_fma_f32 v[112:113], v[112:113], v[136:137], v[132:133] op_sel_hi:[1,0,0]
  v_pk_fma_f32 v[114:115], v[114:115], v[136:137], v[132:133] op_sel_hi:[1,0,0]
  v_pk_fma_f32 v[116:117], v[116:117], v[136:137], v[132:133] op_sel_hi:[1,0,0]
  v_pk_fma_f32 v[118:119], v[118:119], v[136:137], v[132:133] op_sel_hi:[1,0,0]
  v_pk_fma_f32 v[120:121], v[120:121], v[136:137], v[132:133] op_sel_hi:[1,0,0]
  v_pk_fma_f32 v[122:123], v[122:123], v[136:137], v[132:133] op_sel_hi:[1,0,0]
  s_add_u32 m0, s76, 10400
  s_add_u32 s66, s77, 9984
  buffer_load_dwordx4 v7, s[32:35], s66 offen lds
  v_cvt_pk_bf16_f32 v8, v100, v101
  v_cvt_pk_bf16_f32 v9, v102, v103
  v_cvt_pk_bf16_f32 v10, v104, v105
  v_cvt_pk_bf16_f32 v11, v106, v107
  v_cvt_pk_bf16_f32 v12, v108, v109
  v_cvt_pk_bf16_f32 v13, v110, v111
  v_cvt_pk_bf16_f32 v14, v112, v113
  v_cvt_pk_bf16_f32 v15, v114, v115
  v_cvt_pk_bf16_f32 v16, v116, v117
  v_cvt_pk_bf16_f32 v17, v118, v119
  v_cvt_pk_bf16_f32 v18, v120, v121
  v_cvt_pk_bf16_f32 v19, v122, v123
  s_add_u32 m0, s76, 11200
  s_add_u32 s66, s77, 10752
  buffer_load_dwordx4 v7, s[32:35], s66 offen lds
  s_barrier
  s_waitcnt lgkmcnt(6)
  v_smfmac_f32_16x16x64_bf16 v[208:211], v[44:47], a[148:155], v92
  v_smfmac_f32_16x16x64_bf16 v[212:215], v[60:63], a[156:163], v92
  v_cvt_pk_bf16_f32 v232, v220, v221
  v_smfmac_f32_16x16x64_bf16 v[216:219], v[76:79], a[164:171], v92
  v_cvt_pk_bf16_f32 v233, v222, v223
  s_add_u32 m0, s76, 12000
  s_add_u32 s66, s77, 11520
  buffer_load_dwordx4 v7, s[32:35], s66 offen lds
  v_smfmac_f32_16x16x64_bf16 v[208:211], v[48:51], a[172:179], v92
  v_cvt_pk_bf16_f32 v234, v224, v225
  ds_write_b64 v96, v[232:233] offset:38400
  v_smfmac_f32_16x16x64_bf16 v[212:215], v[64:67], a[180:187], v92
  v_cvt_pk_bf16_f32 v235, v226, v227
  v_smfmac_f32_16x16x64_bf16 v[216:219], v[80:83], a[188:195], v92
  v_cvt_pk_bf16_f32 v236, v228, v229
  ds_write_b64 v96, v[234:235] offset:38416
  v_smfmac_f32_16x16x64_bf16 v[208:211], v[52:55], a[100:107], v92
  v_cvt_pk_bf16_f32 v237, v230, v231
  s_add_u32 m0, s76, 12800
  s_add_u32 s66, s77, 12288
  buffer_load_dwordx4 v7, s[32:35], s66 offen lds
  v_smfmac_f32_16x16x64_bf16 v[212:215], v[68:71], a[108:115], v92
  ds_write_b64 v96, v[236:237] offset:38432
  v_smfmac_f32_16x16x64_bf16 v[216:219], v[84:87], a[116:123], v92
  v_smfmac_f32_16x16x64_bf16 v[208:211], v[56:59], a[196:203], v92
  v_smfmac_f32_16x16x64_bf16 v[212:215], v[72:75], a[204:211], v92
  s_add_u32 m0, s76, 13600
  s_add_u32 s66, s77, 13056
  buffer_load_dwordx4 v7, s[32:35], s66 offen lds
  v_smfmac_f32_16x16x64_bf16 v[216:219], v[88:91], a[212:219], v92
  s_nop 4
  s_nop 0
  v_cvt_pk_bf16_f32 v232, v208, v209
  v_cvt_pk_bf16_f32 v233, v210, v211
  ds_write_b64 v96, v[232:233] offset:46080
  v_cvt_pk_bf16_f32 v234, v212, v213
  v_cvt_pk_bf16_f32 v235, v214, v215
  ds_write_b64 v96, v[234:235] offset:46096
  v_cvt_pk_bf16_f32 v236, v216, v217
  v_cvt_pk_bf16_f32 v237, v218, v219
  ds_write_b64 v96, v[236:237] offset:46112
  s_add_u32 m0, s76, 14400
  s_add_u32 s66, s77, 13824
  buffer_load_dwordx4 v7, s[32:35], s66 offen lds
  s_add_u32 m0, s76, 15200
  s_add_u32 s66, s77, 14592
  buffer_load_dwordx4 v7, s[32:35], s66 offen lds
  s_add_u32 m0, s76, 16000
  s_add_u32 s66, s77, 15360
  buffer_load_dwordx4 v7, s[32:35], s66 offen lds
  s_add_u32 m0, s76, 16800
  s_add_u32 s66, s77, 16128
  buffer_load_dwordx4 v7, s[32:35], s66 offen lds
  s_add_u32 m0, s76, 17600
  s_add_u32 s66, s77, 16896
  buffer_load_dwordx4 v7, s[32:35], s66 offen lds
  s_add_u32 m0, s76, 18400
  s_add_u32 s66, s77, 17664
  s_mov_b32 exec_hi, 0xffff
  buffer_load_dwordx4 v7, s[32:35], s66 offen lds
  s_mov_b32 exec_hi, -1
  s_waitcnt lgkmcnt(0)
  s_barrier
  s_nop 0
  ds_read_b64 v[192:193], v99 offset:0
  ds_read_b64 v[194:195], v99 offset:32
  ds_read_b64 v[196:197], v99 offset:64
  ds_read_b64 v[198:199], v99 offset:96
  ds_read_b64 v[200:201], v99 offset:128
  ds_read_b64 v[202:203], v99 offset:160
  ds_read_b64 v[244:245], v5 offset:0
  ds_read_b64 v[246:247], v5 offset:32
  ds_read_b64 v[248:249], v5 offset:64
  ds_read_b64 v[250:251], v5 offset:96
  ds_read_b64 v[252:253], v5 offset:128
  ds_read_b64 v[254:255], v5 offset:160
  s_waitcnt lgkmcnt(6)
  s_nop 0
  v_mfma_f32_16x16x32_bf16 v[124:127], v[192:195], v[192:195], 0
  v_mfma_f32_16x16x32_bf16 v[128:131], a[92:95], v[192:195], 0
  v_mfma_f32_16x16x32_bf16 v[124:127], v[196:199], v[196:199], v[124:127]
  v_mfma_f32_16x16x32_bf16 v[128:131], a[92:95], v[196:199], v[128:131]
  v_mfma_f32_16x16x32_bf16 v[124:127], v[200:203], v[200:203], v[124:127]
  v_mfma_f32_16x16x32_bf16 v[128:131], a[92:95], v[200:203], v[128:131]
  s_waitcnt lgkmcnt(0)
  s_nop 0
  v_mfma_f32_16x16x32_bf16 v[172:175], v[244:247], v[244:247], 0
  v_mfma_f32_16x16x32_bf16 v[176:179], a[92:95], v[244:247], 0
  v_mfma_f32_16x16x32_bf16 v[172:175], v[248:251], v[248:251], v[172:175]
  v_mfma_f32_16x16x32_bf16 v[176:179], a[92:95], v[248:251], v[176:179]
  v_mfma_f32_16x16x32_bf16 v[172:175], v[252:255], v[252:255], v[172:175]
  v_mfma_f32_16x16x32_bf16 v[176:179], a[92:95], v[252:255], v[176:179]
  v_mfma_f32_16x16x32_bf16 v[100:103], a[84:87], v[192:195], 0
  v_mfma_f32_16x16x32_bf16 v[104:107], a[88:91], v[192:195], 0
  v_cndmask_b32 v132, v124, v125, s[54:55]
  v_mfma_f32_16x16x32_bf16 v[108:111], a[84:87], v[196:199], 0
  v_cndmask_b32 v132, v132, v126, s[56:57]
  v_mfma_f32_16x16x32_bf16 v[112:115], a[88:91], v[196:199], 0
  v_cndmask_b32 v132, v132, v127, s[58:59]
  v_mfma_f32_16x16x32_bf16 v[116:119], a[84:87], v[200:203], 0
  v_cndmask_b32 v132, 0, v132, s[60:61]
  v_mfma_f32_16x16x32_bf16 v[120:123], a[88:91], v[200:203], 0
  v_mov_b32_e64 v133, 1.0
  v_mul_f32 v134, 0x3c2aaaab, v128
  s_nop 0
  s_nop 0
  v_mfma_f32_16x16x4_f32 v[124:127], v133, v132, 0
  v_mfma_f32_16x16x32_bf16 v[148:151], a[84:87], v[244:247], 0
  v_cndmask_b32 v180, v172, v173, s[54:55]
  v_mfma_f32_16x16x32_bf16 v[152:155], a[88:91], v[244:247], 0
  v_cndmask_b32 v180, v180, v174, s[56:57]
  v_mfma_f32_16x16x32_bf16 v[156:159], a[84:87], v[248:251], 0
  v_cndmask_b32 v180, v180, v175, s[58:59]
  v_mfma_f32_16x16x32_bf16 v[160:163], a[88:91], v[248:251], 0
  v_cndmask_b32 v180, 0, v180, s[60:61]
  v_mfma_f32_16x16x32_bf16 v[164:167], a[84:87], v[252:255], 0
  v_mov_b32_e64 v181, 1.0
  v_mfma_f32_16x16x32_bf16 v[168:171], a[88:91], v[252:255], 0
  v_mul_f32 v182, 0x3c2aaaab, v176
  v_mfma_f32_16x16x4_f32 v[172:175], v181, v180, 0
  v_mul_f32 v135, 0x3c2aaaab, v124
  v_fma_f32 v135, -v134, v134, v135
  v_max_f32_e64 v135, 0, v135
  v_add_f32 v135, 0x3727c5ac, v135
  v_rsq_f32_e64 v135, v135
  v_mul_f32 v134, 0x3eeff558, v134
  v_mul_f32 v136, 0xbeeff558, v135
  v_mul_f32 v132, v134, v135
  s_nop 1
  v_mul_f32 v183, 0x3c2aaaab, v172
  v_fma_f32 v183, -v182, v182, v183
  v_pk_fma_f32 v[100:101], v[100:101], v[136:137], v[132:133] op_sel_hi:[1,0,0]
  v_max_f32_e64 v183, 0, v183
  v_pk_fma_f32 v[102:103], v[102:103], v[136:137], v[132:133] op_sel_hi:[1,0,0]
  v_add_f32 v183, 0x3727c5ac, v183
  v_pk_fma_f32 v[104:105], v[104:105], v[136:137], v[132:133] op_sel_hi:[1,0,0]
  v_rsq_f32_e64 v183, v183
  v_pk_fma_f32 v[106:107], v[106:107], v[136:137], v[132:133] op_sel_hi:[1,0,0]
  v_mul_f32 v182, 0x3eeff558, v182
  v_pk_fma_f32 v[108:109], v[108:109], v[136:137], v[132:133] op_sel_hi:[1,0,0]
  v_mul_f32 v184, 0xbeeff558, v183
  v_pk_fma_f32 v[110:111], v[110:111], v[136:137], v[132:133] op_sel_hi:[1,0,0]
  v_mul_f32_e64 v180, v182, v183
  v_pk_fma_f32 v[112:113], v[112:113], v[136:137], v[132:133] op_sel_hi:[1,0,0]
  v_pk_fma_f32 v[114:115], v[114:115], v[136:137], v[132:133] op_sel_hi:[1,0,0]
  v_pk_fma_f32 v[116:117], v[116:117], v[136:137], v[132:133] op_sel_hi:[1,0,0]
  v_pk_fma_f32 v[118:119], v[118:119], v[136:137], v[132:133] op_sel_hi:[1,0,0]
  v_pk_fma_f32 v[120:121], v[120:121], v[136:137], v[132:133] op_sel_hi:[1,0,0]
  v_pk_fma_f32 v[122:123], v[122:123], v[136:137], v[132:133] op_sel_hi:[1,0,0]
  v_cvt_pk_bf16_f32 v20, v100, v101
  v_cvt_pk_bf16_f32 v21, v102, v103
  v_cvt_pk_bf16_f32 v22, v104, v105
  v_cvt_pk_bf16_f32 v23, v106, v107
  v_pk_fma_f32 v[148:149], v[148:149], v[184:185], v[180:181] op_sel_hi:[1,0,0]
  v_pk_fma_f32 v[150:151], v[150:151], v[184:185], v[180:181] op_sel_hi:[1,0,0]
  v_pk_fma_f32 v[152:153], v[152:153], v[184:185], v[180:181] op_sel_hi:[1,0,0]
  v_pk_fma_f32 v[154:155], v[154:155], v[184:185], v[180:181] op_sel_hi:[1,0,0]
  v_pk_fma_f32 v[156:157], v[156:157], v[184:185], v[180:181] op_sel_hi:[1,0,0]
  v_pk_fma_f32 v[158:159], v[158:159], v[184:185], v[180:181] op_sel_hi:[1,0,0]
  v_pk_fma_f32 v[160:161], v[160:161], v[184:185], v[180:181] op_sel_hi:[1,0,0]
  v_pk_fma_f32 v[162:163], v[162:163], v[184:185], v[180:181] op_sel_hi:[1,0,0]
  v_pk_fma_f32 v[164:165], v[164:165], v[184:185], v[180:181] op_sel_hi:[1,0,0]
  v_pk_fma_f32 v[166:167], v[166:167], v[184:185], v[180:181] op_sel_hi:[1,0,0]
  v_pk_fma_f32 v[168:169], v[168:169], v[184:185], v[180:181] op_sel_hi:[1,0,0]
  v_pk_fma_f32 v[170:171], v[170:171], v[184:185], v[180:181] op_sel_hi:[1,0,0]
  v_cvt_pk_bf16_f32 v24, v108, v109
  v_cvt_pk_bf16_f32 v25, v110, v111
  v_cvt_pk_bf16_f32 v26, v112, v113
  v_cvt_pk_bf16_f32 v27, v114, v115
  v_cvt_pk_bf16_f32 v28, v116, v117
  v_cvt_pk_bf16_f32 v29, v118, v119
  v_cvt_pk_bf16_f32 v30, v120, v121
  v_cvt_pk_bf16_f32 v31, v122, v123
  v_cvt_pk_bf16_f32 v32, v148, v149
  v_cvt_pk_bf16_f32 v33, v150, v151
  v_cvt_pk_bf16_f32 v34, v152, v153
  v_cvt_pk_bf16_f32 v35, v154, v155
  v_cvt_pk_bf16_f32 v36, v156, v157
  v_cvt_pk_bf16_f32 v37, v158, v159
  v_cvt_pk_bf16_f32 v38, v160, v161
  v_cvt_pk_bf16_f32 v39, v162, v163
  v_cvt_pk_bf16_f32 v40, v164, v165
  v_cvt_pk_bf16_f32 v41, v166, v167
  v_cvt_pk_bf16_f32 v42, v168, v169
  v_cvt_pk_bf16_f32 v43, v170, v171
  v_lshrrev_b32_e64 v6, 2, v2
  v_lshl_add_u32 v6, v3, 2, v6
  v_mul_u32_u24 v6, 800, v6
  v_and_b32_e64 v7, 3, v2
  v_lshl_add_u32 v6, v7, 3, v6
  s_add_u32 s66, s44, 0
  s_and_b32 s66, s66, 3
  s_mul_i32 s66, s66, 192
  v_add_u32_e64 v4, s66, v6
  v_accvgpr_read_b32 v93, a0
  v_accvgpr_read_b32 v94, a1
  v_accvgpr_read_b32 v95, a2
  s_mul_i32 s76, s44, 18432
  s_add_u32 s77, s76, 76800
  v_mov_b32 v87, 0
  v_mov_b32 v88, 0
  v_mov_b32 v89, 0
  v_mov_b32 v90, 0
  v_mov_b32 v91, 0
  v_mov_b32 v92, 0
  s_waitcnt vmcnt(0)
  s_barrier
  ds_read_b64_tr_b16 a[72:73], v4 offset:0
  ds_read_b64_tr_b16 a[74:75], v4 offset:12800
  ds_read_b64_tr_b16 a[76:77], v4 offset:25600
  ds_read_b64_tr_b16 a[78:79], v4 offset:38400
  ds_read_b64_tr_b16 a[80:81], v4 offset:51200
  ds_read_b64_tr_b16 a[82:83], v4 offset:64000
  s_waitcnt lgkmcnt(0)
  s_nop 0
  v_mfma_f32_16x16x32_bf16 v[44:47], a[72:75], v[8:11], 0
  v_mfma_f32_16x16x32_bf16 v[48:51], a[72:75], v[20:23], 0
  v_mfma_f32_16x16x32_bf16 v[52:55], a[72:75], v[32:35], 0
  v_mfma_f32_16x16x32_bf16 v[192:195], a[72:75], v[140:143], 0
  v_mfma_f32_16x16x32_bf16 v[44:47], a[76:79], v[12:15], v[44:47]
  v_mfma_f32_16x16x32_bf16 v[48:51], a[76:79], v[24:27], v[48:51]
  v_mfma_f32_16x16x32_bf16 v[52:55], a[76:79], v[36:39], v[52:55]
  v_mfma_f32_16x16x32_bf16 v[192:195], a[76:79], v[144:147], v[192:195]
  v_mfma_f32_16x16x32_bf16 v[44:47], a[80:83], v[16:19], v[44:47]
  v_mfma_f32_16x16x32_bf16 v[48:51], a[80:83], v[28:31], v[48:51]
  v_mfma_f32_16x16x32_bf16 v[52:55], a[80:83], v[40:43], v[52:55]
  v_mfma_f32_16x16x32_bf16 v[192:195], a[80:83], v[188:191], v[192:195]
  ds_read_b64_tr_b16 a[72:73], v4 offset:32
  ds_read_b64_tr_b16 a[74:75], v4 offset:12832
  ds_read_b64_tr_b16 a[76:77], v4 offset:25632
  ds_read_b64_tr_b16 a[78:79], v4 offset:38432
  ds_read_b64_tr_b16 a[80:81], v4 offset:51232
  ds_read_b64_tr_b16 a[82:83], v4 offset:64032
  s_nop 3
  s_nop 0
  v_pk_fma_f32 v[68:69], v[44:45], v[44:45], s[50:51]
  v_pk_fma_f32 v[70:71], v[46:47], v[46:47], s[50:51]
  v_pk_fma_f32 v[72:73], v[48:49], v[48:49], s[50:51]
  v_pk_fma_f32 v[74:75], v[50:51], v[50:51], s[50:51]
  v_pk_fma_f32 v[76:77], v[52:53], v[52:53], s[50:51]
  v_pk_fma_f32 v[78:79], v[54:55], v[54:55], s[50:51]
  v_pk_fma_f32 v[240:241], v[192:193], v[192:193], s[50:51]
  v_pk_fma_f32 v[242:243], v[194:195], v[194:195], s[50:51]
  v_pk_mul_f32 v[68:69], v[68:69], v[44:45]
  v_pk_mul_f32 v[70:71], v[70:71], v[46:47]
  v_pk_mul_f32 v[72:73], v[72:73], v[48:49]
  v_pk_mul_f32 v[74:75], v[74:75], v[50:51]
  v_pk_mul_f32 v[76:77], v[76:77], v[52:53]
  v_pk_mul_f32 v[78:79], v[78:79], v[54:55]
  v_pk_mul_f32 v[240:241], v[240:241], v[192:193]
  v_pk_mul_f32 v[242:243], v[242:243], v[194:195]
  s_waitcnt lgkmcnt(0)
  v_mfma_f32_16x16x32_bf16 v[56:59], a[72:75], v[8:11], 0
  v_exp_f32 v68, v68
  v_mfma_f32_16x16x32_bf16 v[60:63], a[72:75], v[20:23], 0
  v_exp_f32_e64 v69, v69
  v_mfma_f32_16x16x32_bf16 v[64:67], a[72:75], v[32:35], 0
  v_exp_f32_e64 v70, v70
  v_mfma_f32_16x16x32_bf16 v[236:239], a[72:75], v[140:143], 0
  v_exp_f32_e64 v71, v71
  v_mfma_f32_16x16x32_bf16 v[56:59], a[76:79], v[12:15], v[56:59]
  v_exp_f32_e64 v72, v72
  v_mfma_f32_16x16x32_bf16 v[60:63], a[76:79], v[24:27], v[60:63]
  v_exp_f32_e64 v73, v73
  v_mfma_f32_16x16x32_bf16 v[64:67], a[76:79], v[36:39], v[64:67]
  v_exp_f32_e64 v74, v74
  v_mfma_f32_16x16x32_bf16 v[236:239], a[76:79], v[144:147], v[236:239]
  v_exp_f32_e64 v75, v75
  v_mfma_f32_16x16x32_bf16 v[56:59], a[80:83], v[16:19], v[56:59]
  v_exp_f32_e64 v76, v76
  v_mfma_f32_16x16x32_bf16 v[60:63], a[80:83], v[28:31], v[60:63]
  v_exp_f32_e64 v77, v77
  v_mfma_f32_16x16x32_bf16 v[64:67], a[80:83], v[40:43], v[64:67]
  v_exp_f32_e64 v78, v78
  v_mfma_f32_16x16x32_bf16 v[236:239], a[80:83], v[188:191], v[236:239]
  ds_read_b64_tr_b16 a[72:73], v4 offset:64
  ds_read_b64_tr_b16 a[74:75], v4 offset:12864
  ds_read_b64_tr_b16 a[76:77], v4 offset:25664
  ds_read_b64_tr_b16 a[78:79], v4 offset:38464
  ds_read_b64_tr_b16 a[80:81], v4 offset:51264
  ds_read_b64_tr_b16 a[82:83], v4 offset:64064
  v_exp_f32 v79, v79
  v_exp_f32 v240, v240
  v_exp_f32 v241, v241
  v_exp_f32 v242, v242
  v_exp_f32_e64 v243, v243
  v_pk_add_f32 v[68:69], v[68:69], 1.0 op_sel_hi:[1,0]
  v_pk_add_f32 v[70:71], v[70:71], 1.0 op_sel_hi:[1,0]
  v_pk_add_f32 v[72:73], v[72:73], 1.0 op_sel_hi:[1,0]
  v_pk_add_f32 v[74:75], v[74:75], 1.0 op_sel_hi:[1,0]
  v_pk_add_f32 v[76:77], v[76:77], 1.0 op_sel_hi:[1,0]
  v_pk_add_f32 v[78:79], v[78:79], 1.0 op_sel_hi:[1,0]
  v_pk_add_f32 v[240:241], v[240:241], 1.0 op_sel_hi:[1,0]
  v_pk_add_f32 v[242:243], v[242:243], 1.0 op_sel_hi:[1,0]
  v_rcp_f32 v68, v68
  v_rcp_f32 v69, v69
  v_rcp_f32 v70, v70
  v_rcp_f32 v71, v71
  v_rcp_f32 v72, v72
  v_rcp_f32 v73, v73
  v_rcp_f32 v74, v74
  v_rcp_f32 v75, v75
  v_rcp_f32 v76, v76
  v_rcp_f32 v77, v77
  v_rcp_f32 v78, v78
  v_rcp_f32 v79, v79
  v_rcp_f32 v240, v240
  v_rcp_f32 v241, v241
  v_rcp_f32 v242, v242
  v_rcp_f32 v243, v243
  v_pk_mul_f32 v[68:69], v[68:69], v[44:45]
  v_pk_mul_f32 v[70:71], v[70:71], v[46:47]
  v_pk_mul_f32 v[72:73], v[72:73], v[48:49]
  v_pk_mul_f32 v[74:75], v[74:75], v[50:51]
  v_pk_mul_f32 v[76:77], v[76:77], v[52:53]
  v_pk_mul_f32 v[78:79], v[78:79], v[54:55]
  v_pk_mul_f32 v[240:241], v[240:241], v[192:193]
  v_pk_mul_f32 v[242:243], v[242:243], v[194:195]
  v_pk_mul_f32 v[80:81], v[68:69], v[68:69]
  v_pk_mul_f32 v[82:83], v[70:71], v[70:71]
  v_pk_fma_f32 v[80:81], v[72:73], v[72:73], v[80:81]
  v_pk_fma_f32 v[82:83], v[74:75], v[74:75], v[82:83]
  v_pk_fma_f32 v[80:81], v[76:77], v[76:77], v[80:81]
  v_pk_fma_f32 v[82:83], v[78:79], v[78:79], v[82:83]
  v_pk_fma_f32 v[80:81], v[240:241], v[240:241], v[80:81]
  v_pk_fma_f32 v[82:83], v[242:243], v[242:243], v[82:83]
  v_cvt_pk_bf16_f32 v100, v68, v69
  v_cvt_pk_bf16_f32 v101, v70, v71
  v_cvt_pk_bf16_f32 v148, v72, v73
  v_cvt_pk_bf16_f32 v149, v74, v75
  v_cvt_pk_bf16_f32 v196, v76, v77
  v_cvt_pk_bf16_f32 v197, v78, v79
  v_cvt_pk_bf16_f32 v244, v240, v241
  v_cvt_pk_bf16_f32 v245, v242, v243
  v_pk_fma_f32 v[68:69], v[56:57], v[56:57], s[50:51]
  v_add_f32_dpp v84, v80, v80 row_ror:8 row_mask:0xf bank_mask:0x3
  v_add_f32_dpp v84, v81, v81 row_ror:8 row_mask:0xf bank_mask:0xc
  v_pk_fma_f32 v[70:71], v[58:59], v[58:59], s[50:51]
  v_add_f32_dpp v85, v82, v82 row_ror:8 row_mask:0xf bank_mask:0x3
  v_add_f32_dpp v85, v83, v83 row_ror:8 row_mask:0xf bank_mask:0xc
  v_pk_fma_f32 v[72:73], v[60:61], v[60:61], s[50:51]
  v_pk_fma_f32 v[74:75], v[62:63], v[62:63], s[50:51]
  v_add_f32_dpp v86, v84, v84 row_half_mirror row_mask:0xf bank_mask:0x5
  v_add_f32_dpp v86, v85, v85 row_half_mirror row_mask:0xf bank_mask:0xa
  v_pk_fma_f32 v[76:77], v[64:65], v[64:65], s[50:51]
  v_pk_fma_f32 v[78:79], v[66:67], v[66:67], s[50:51]
  v_pk_fma_f32 v[240:241], v[236:237], v[236:237], s[50:51]
  v_add_f32_dpp v86, v86, v86 quad_perm:[1,0,3,2] row_mask:0xf bank_mask:0xf
  v_pk_fma_f32 v[242:243], v[238:239], v[238:239], s[50:51]
  v_pk_mul_f32 v[68:69], v[68:69], v[56:57]
  v_pk_mul_f32 v[70:71], v[70:71], v[58:59]
  v_add_f32_dpp v86, v86, v86 quad_perm:[2,3,0,1] row_mask:0xf bank_mask:0xf
  v_pk_mul_f32 v[72:73], v[72:73], v[60:61]
  v_pk_mul_f32 v[74:75], v[74:75], v[62:63]
  v_cndmask_b32 v87, v87, v86, s[52:53]
  v_pk_mul_f32 v[76:77], v[76:77], v[64:65]
  v_pk_mul_f32 v[78:79], v[78:79], v[66:67]
  v_pk_mul_f32 v[240:241], v[240:241], v[236:237]
  v_pk_mul_f32 v[242:243], v[242:243], v[238:239]
  s_waitcnt lgkmcnt(0)
  v_mfma_f32_16x16x32_bf16 v[44:47], a[72:75], v[8:11], 0
  v_exp_f32 v68, v68
  v_mfma_f32_16x16x32_bf16 v[48:51], a[72:75], v[20:23], 0
  s_add_u32 m0, s77, 0
  s_add_u32 s67, s76, 0
  buffer_load_dwordx4 v93, s[36:39], s67 offen offset:0 lds
  v_exp_f32_e64 v69, v69
  v_mfma_f32_16x16x32_bf16 v[52:55], a[72:75], v[32:35], 0
  v_exp_f32_e64 v70, v70
  v_mfma_f32_16x16x32_bf16 v[192:195], a[72:75], v[140:143], 0
  v_exp_f32_e64 v71, v71
  v_mfma_f32_16x16x32_bf16 v[44:47], a[76:79], v[12:15], v[44:47]
  v_exp_f32_e64 v72, v72
  v_mfma_f32_16x16x32_bf16 v[48:51], a[76:79], v[24:27], v[48:51]
  v_exp_f32_e64 v73, v73
  v_mfma_f32_16x16x32_bf16 v[52:55], a[76:79], v[36:39], v[52:55]
  v_exp_f32_e64 v74, v74
  v_mfma_f32_16x16x32_bf16 v[192:195], a[76:79], v[144:147], v[192:195]
  v_exp_f32_e64 v75, v75
  v_mfma_f32_16x16x32_bf16 v[44:47], a[80:83], v[16:19], v[44:47]
  v_exp_f32_e64 v76, v76
  v_mfma_f32_16x16x32_bf16 v[48:51], a[80:83], v[28:31], v[48:51]
  v_exp_f32_e64 v77, v77
  v_mfma_f32_16x16x32_bf16 v[52:55], a[80:83], v[40:43], v[52:55]
  v_exp_f32_e64 v78, v78
  v_mfma_f32_16x16x32_bf16 v[192:195], a[80:83], v[188:191], v[192:195]
  ds_read_b64_tr_b16 a[72:73], v4 offset:96
  ds_read_b64_tr_b16 a[74:75], v4 offset:12896
  ds_read_b64_tr_b16 a[76:77], v4 offset:25696
  ds_read_b64_tr_b16 a[78:79], v4 offset:38496
  ds_read_b64_tr_b16 a[80:81], v4 offset:51296
  ds_read_b64_tr_b16 a[82:83], v4 offset:64096
  v_exp_f32 v79, v79
  v_exp_f32 v240, v240
  v_exp_f32 v241, v241
  v_exp_f32 v242, v242
  v_exp_f32_e64 v243, v243
  v_pk_add_f32 v[68:69], v[68:69], 1.0 op_sel_hi:[1,0]
  v_pk_add_f32 v[70:71], v[70:71], 1.0 op_sel_hi:[1,0]
  v_pk_add_f32 v[72:73], v[72:73], 1.0 op_sel_hi:[1,0]
  v_pk_add_f32 v[74:75], v[74:75], 1.0 op_sel_hi:[1,0]
  v_pk_add_f32 v[76:77], v[76:77], 1.0 op_sel_hi:[1,0]
  v_pk_add_f32 v[78:79], v[78:79], 1.0 op_sel_hi:[1,0]
  v_pk_add_f32 v[240:241], v[240:241], 1.0 op_sel_hi:[1,0]
  v_pk_add_f32 v[242:243], v[242:243], 1.0 op_sel_hi:[1,0]
  v_rcp_f32 v68, v68
  v_rcp_f32 v69, v69
  v_rcp_f32 v70, v70
  v_rcp_f32 v71, v71
  v_rcp_f32 v72, v72
  v_rcp_f32 v73, v73
  v_rcp_f32 v74, v74
  v_rcp_f32 v75, v75
  v_rcp_f32 v76, v76
  v_rcp_f32 v77, v77
  v_rcp_f32 v78, v78
  v_rcp_f32 v79, v79
  v_rcp_f32 v240, v240
  v_rcp_f32 v241, v241
  v_rcp_f32 v242, v242
  v_rcp_f32 v243, v243
  v_pk_mul_f32 v[68:69], v[68:69], v[56:57]
  v_pk_mul_f32 v[70:71], v[70:71], v[58:59]
  v_pk_mul_f32 v[72:73], v[72:73], v[60:61]
  v_pk_mul_f32 v[74:75], v[74:75], v[62:63]
  v_pk_mul_f32 v[76:77], v[76:77], v[64:65]
  v_pk_mul_f32 v[78:79], v[78:79], v[66:67]
  v_pk_mul_f32 v[240:241], v[240:241], v[236:237]
  v_pk_mul_f32 v[242:243], v[242:243], v[238:239]
  v_pk_mul_f32 v[80:81], v[68:69], v[68:69]
  v_pk_mul_f32 v[82:83], v[70:71], v[70:71]
  v_pk_fma_f32 v[80:81], v[72:73], v[72:73], v[80:81]
  v_pk_fma_f32 v[82:83], v[74:75], v[74:75], v[82:83]
  v_pk_fma_f32 v[80:81], v[76:77], v[76:77], v[80:81]
  v_pk_fma_f32 v[82:83], v[78:79], v[78:79], v[82:83]
  v_pk_fma_f32 v[80:81], v[240:241], v[240:241], v[80:81]
  v_pk_fma_f32 v[82:83], v[242:243], v[242:243], v[82:83]
  v_cvt_pk_bf16_f32 v102, v68, v69
  v_cvt_pk_bf16_f32 v103, v70, v71
  v_cvt_pk_bf16_f32 v150, v72, v73
  v_cvt_pk_bf16_f32 v151, v74, v75
  v_cvt_pk_bf16_f32 v198, v76, v77
  v_cvt_pk_bf16_f32 v199, v78, v79
  v_cvt_pk_bf16_f32 v246, v240, v241
  v_cvt_pk_bf16_f32 v247, v242, v243
  v_pk_fma_f32 v[68:69], v[44:45], v[44:45], s[50:51]
  v_add_f32_dpp v84, v80, v80 row_ror:8 row_mask:0xf bank_mask:0x3
  v_add_f32_dpp v84, v81, v81 row_ror:8 row_mask:0xf bank_mask:0xc
  v_pk_fma_f32 v[70:71], v[46:47], v[46:47], s[50:51]
  v_add_f32_dpp v85, v82, v82 row_ror:8 row_mask:0xf bank_mask:0x3
  v_add_f32_dpp v85, v83, v83 row_ror:8 row_mask:0xf bank_mask:0xc
  v_pk_fma_f32 v[72:73], v[48:49], v[48:49], s[50:51]
  v_pk_fma_f32 v[74:75], v[50:51], v[50:51], s[50:51]
  v_add_f32_dpp v86, v84, v84 row_half_mirror row_mask:0xf bank_mask:0x5
  v_add_f32_dpp v86, v85, v85 row_half_mirror row_mask:0xf bank_mask:0xa
  v_pk_fma_f32 v[76:77], v[52:53], v[52:53], s[50:51]
  v_pk_fma_f32 v[78:79], v[54:55], v[54:55], s[50:51]
  v_pk_fma_f32 v[240:241], v[192:193], v[192:193], s[50:51]
  v_add_f32_dpp v86, v86, v86 quad_perm:[1,0,3,2] row_mask:0xf bank_mask:0xf
  v_pk_fma_f32 v[242:243], v[194:195], v[194:195], s[50:51]
  v_pk_mul_f32 v[68:69], v[68:69], v[44:45]
  v_pk_mul_f32 v[70:71], v[70:71], v[46:47]
  v_add_f32_dpp v86, v86, v86 quad_perm:[2,3,0,1] row_mask:0xf bank_mask:0xf
  v_pk_mul_f32 v[72:73], v[72:73], v[48:49]
  v_pk_mul_f32 v[74:75], v[74:75], v[50:51]
  v_cndmask_b32 v87, v87, v86, s[54:55]
  v_pk_mul_f32 v[76:77], v[76:77], v[52:53]
  v_pk_mul_f32 v[78:79], v[78:79], v[54:55]
  v_pk_mul_f32 v[240:241], v[240:241], v[192:193]
  v_pk_mul_f32 v[242:243], v[242:243], v[194:195]
  s_waitcnt lgkmcnt(0)
  v_mfma_f32_16x16x32_bf16 v[56:59], a[72:75], v[8:11], 0
  v_exp_f32 v68, v68
  v_mfma_f32_16x16x32_bf16 v[60:63], a[72:75], v[20:23], 0
  buffer_load_dwordx4 v94, s[36:39], s67 offen offset:1024 lds
  v_exp_f32_e64 v69, v69
  v_mfma_f32_16x16x32_bf16 v[64:67], a[72:75], v[32:35], 0
  v_exp_f32_e64 v70, v70
  v_mfma_f32_16x16x32_bf16 v[236:239], a[72:75], v[140:143], 0
  v_exp_f32_e64 v71, v71
  v_mfma_f32_16x16x32_bf16 v[56:59], a[76:79], v[12:15], v[56:59]
  v_exp_f32_e64 v72, v72
  v_mfma_f32_16x16x32_bf16 v[60:63], a[76:79], v[24:27], v[60:63]
  v_exp_f32_e64 v73, v73
  v_mfma_f32_16x16x32_bf16 v[64:67], a[76:79], v[36:39], v[64:67]
  v_exp_f32_e64 v74, v74
  v_mfma_f32_16x16x32_bf16 v[236:239], a[76:79], v[144:147], v[236:239]
  v_exp_f32_e64 v75, v75
  v_mfma_f32_16x16x32_bf16 v[56:59], a[80:83], v[16:19], v[56:59]
  v_exp_f32_e64 v76, v76
  v_mfma_f32_16x16x32_bf16 v[60:63], a[80:83], v[28:31], v[60:63]
  v_exp_f32_e64 v77, v77
  v_mfma_f32_16x16x32_bf16 v[64:67], a[80:83], v[40:43], v[64:67]
  v_exp_f32_e64 v78, v78
  v_mfma_f32_16x16x32_bf16 v[236:239], a[80:83], v[188:191], v[236:239]
  ds_read_b64_tr_b16 a[72:73], v4 offset:128
  ds_read_b64_tr_b16 a[74:75], v4 offset:12928
  ds_read_b64_tr_b16 a[76:77], v4 offset:25728
  ds_read_b64_tr_b16 a[78:79], v4 offset:38528
  ds_read_b64_tr_b16 a[80:81], v4 offset:51328
  ds_read_b64_tr_b16 a[82:83], v4 offset:64128
  v_exp_f32 v79, v79
  v_exp_f32 v240, v240
  v_exp_f32 v241, v241
  v_exp_f32 v242, v242
  v_exp_f32_e64 v243, v243
  v_pk_add_f32 v[68:69], v[68:69], 1.0 op_sel_hi:[1,0]
  v_pk_add_f32 v[70:71], v[70:71], 1.0 op_sel_hi:[1,0]
  v_pk_add_f32 v[72:73], v[72:73], 1.0 op_sel_hi:[1,0]
  v_pk_add_f32 v[74:75], v[74:75], 1.0 op_sel_hi:[1,0]
  v_pk_add_f32 v[76:77], v[76:77], 1.0 op_sel_hi:[1,0]
  v_pk_add_f32 v[78:79], v[78:79], 1.0 op_sel_hi:[1,0]
  v_pk_add_f32 v[240:241], v[240:241], 1.0 op_sel_hi:[1,0]
  v_pk_add_f32 v[242:243], v[242:243], 1.0 op_sel_hi:[1,0]
  v_rcp_f32 v68, v68
  v_rcp_f32 v69, v69
  v_rcp_f32 v70, v70
  v_rcp_f32 v71, v71
  v_rcp_f32 v72, v72
  v_rcp_f32 v73, v73
  v_rcp_f32 v74, v74
  v_rcp_f32 v75, v75
  v_rcp_f32 v76, v76
  v_rcp_f32 v77, v77
  v_rcp_f32 v78, v78
  v_rcp_f32 v79, v79
  v_rcp_f32 v240, v240
  v_rcp_f32 v241, v241
  v_rcp_f32 v242, v242
  v_rcp_f32 v243, v243
  v_pk_mul_f32 v[68:69], v[68:69], v[44:45]
  v_pk_mul_f32 v[70:71], v[70:71], v[46:47]
  v_pk_mul_f32 v[72:73], v[72:73], v[48:49]
  v_pk_mul_f32 v[74:75], v[74:75], v[50:51]
  v_pk_mul_f32 v[76:77], v[76:77], v[52:53]
  v_pk_mul_f32 v[78:79], v[78:79], v[54:55]
  v_pk_mul_f32 v[240:241], v[240:241], v[192:193]
  v_pk_mul_f32 v[242:243], v[242:243], v[194:195]
  v_pk_mul_f32 v[80:81], v[68:69], v[68:69]
  v_pk_mul_f32 v[82:83], v[70:71], v[70:71]
  v_pk_fma_f32 v[80:81], v[72:73], v[72:73], v[80:81]
  v_pk_fma_f32 v[82:83], v[74:75], v[74:75], v[82:83]
  v_pk_fma_f32 v[80:81], v[76:77], v[76:77], v[80:81]
  v_pk_fma_f32 v[82:83], v[78:79], v[78:79], v[82:83]
  v_pk_fma_f32 v[80:81], v[240:241], v[240:241], v[80:81]
  v_pk_fma_f32 v[82:83], v[242:243], v[242:243], v[82:83]
  v_cvt_pk_bf16_f32 v104, v68, v69
  v_cvt_pk_bf16_f32 v105, v70, v71
  v_cvt_pk_bf16_f32 v152, v72, v73
  v_cvt_pk_bf16_f32 v153, v74, v75
  v_cvt_pk_bf16_f32 v200, v76, v77
  v_cvt_pk_bf16_f32 v201, v78, v79
  v_cvt_pk_bf16_f32 v248, v240, v241
  v_cvt_pk_bf16_f32 v249, v242, v243
  v_pk_fma_f32 v[68:69], v[56:57], v[56:57], s[50:51]
  v_add_f32_dpp v84, v80, v80 row_ror:8 row_mask:0xf bank_mask:0x3
  v_add_f32_dpp v84, v81, v81 row_ror:8 row_mask:0xf bank_mask:0xc
  v_pk_fma_f32 v[70:71], v[58:59], v[58:59], s[50:51]
  v_add_f32_dpp v85, v82, v82 row_ror:8 row_mask:0xf bank_mask:0x3
  v_add_f32_dpp v85, v83, v83 row_ror:8 row_mask:0xf bank_mask:0xc
  v_pk_fma_f32 v[72:73], v[60:61], v[60:61], s[50:51]
  v_pk_fma_f32 v[74:75], v[62:63], v[62:63], s[50:51]
  v_add_f32_dpp v86, v84, v84 row_half_mirror row_mask:0xf bank_mask:0x5
  v_add_f32_dpp v86, v85, v85 row_half_mirror row_mask:0xf bank_mask:0xa
  v_pk_fma_f32 v[76:77], v[64:65], v[64:65], s[50:51]
  v_pk_fma_f32 v[78:79], v[66:67], v[66:67], s[50:51]
  v_pk_fma_f32 v[240:241], v[236:237], v[236:237], s[50:51]
  v_add_f32_dpp v86, v86, v86 quad_perm:[1,0,3,2] row_mask:0xf bank_mask:0xf
  v_pk_fma_f32 v[242:243], v[238:239], v[238:239], s[50:51]
  v_pk_mul_f32 v[68:69], v[68:69], v[56:57]
  v_pk_mul_f32 v[70:71], v[70:71], v[58:59]
  v_add_f32_dpp v86, v86, v86 quad_perm:[2,3,0,1] row_mask:0xf bank_mask:0xf
  v_pk_mul_f32 v[72:73], v[72:73], v[60:61]
  v_pk_mul_f32 v[74:75], v[74:75], v[62:63]
  v_cndmask_b32 v87, v87, v86, s[56:57]
  v_pk_mul_f32 v[76:77], v[76:77], v[64:65]
  v_pk_mul_f32 v[78:79], v[78:79], v[66:67]
  v_pk_mul_f32 v[240:241], v[240:241], v[236:237]
  v_pk_mul_f32 v[242:243], v[242:243], v[238:239]
  s_waitcnt lgkmcnt(0)
  v_mfma_f32_16x16x32_bf16 v[44:47], a[72:75], v[8:11], 0
  v_exp_f32 v68, v68
  v_mfma_f32_16x16x32_bf16 v[48:51], a[72:75], v[20:23], 0
  buffer_load_dwordx4 v95, s[36:39], s67 offen offset:2048 lds
  v_exp_f32_e64 v69, v69
  v_mfma_f32_16x16x32_bf16 v[52:55], a[72:75], v[32:35], 0
  v_exp_f32_e64 v70, v70
  v_mfma_f32_16x16x32_bf16 v[192:195], a[72:75], v[140:143], 0
  v_exp_f32_e64 v71, v71
  v_mfma_f32_16x16x32_bf16 v[44:47], a[76:79], v[12:15], v[44:47]
  v_exp_f32_e64 v72, v72
  v_mfma_f32_16x16x32_bf16 v[48:51], a[76:79], v[24:27], v[48:51]
  v_exp_f32_e64 v73, v73
  v_mfma_f32_16x16x32_bf16 v[52:55], a[76:79], v[36:39], v[52:55]
  v_exp_f32_e64 v74, v74
  v_mfma_f32_16x16x32_bf16 v[192:195], a[76:79], v[144:147], v[192:195]
  v_exp_f32_e64 v75, v75
  v_mfma_f32_16x16x32_bf16 v[44:47], a[80:83], v[16:19], v[44:47]
  v_exp_f32_e64 v76, v76
  v_mfma_f32_16x16x32_bf16 v[48:51], a[80:83], v[28:31], v[48:51]
  v_exp_f32_e64 v77, v77
  v_mfma_f32_16x16x32_bf16 v[52:55], a[80:83], v[40:43], v[52:55]
  v_exp_f32_e64 v78, v78
  v_mfma_f32_16x16x32_bf16 v[192:195], a[80:83], v[188:191], v[192:195]
  ds_read_b64_tr_b16 a[72:73], v4 offset:160
  ds_read_b64_tr_b16 a[74:75], v4 offset:12960
  ds_read_b64_tr_b16 a[76:77], v4 offset:25760
  ds_read_b64_tr_b16 a[78:79], v4 offset:38560
  ds_read_b64_tr_b16 a[80:81], v4 offset:51360
  ds_read_b64_tr_b16 a[82:83], v4 offset:64160
  v_exp_f32 v79, v79
  v_exp_f32 v240, v240
  v_exp_f32 v241, v241
  v_exp_f32 v242, v242
  v_exp_f32_e64 v243, v243
  v_pk_add_f32 v[68:69], v[68:69], 1.0 op_sel_hi:[1,0]
  v_pk_add_f32 v[70:71], v[70:71], 1.0 op_sel_hi:[1,0]
  v_pk_add_f32 v[72:73], v[72:73], 1.0 op_sel_hi:[1,0]
  v_pk_add_f32 v[74:75], v[74:75], 1.0 op_sel_hi:[1,0]
  v_pk_add_f32 v[76:77], v[76:77], 1.0 op_sel_hi:[1,0]
  v_pk_add_f32 v[78:79], v[78:79], 1.0 op_sel_hi:[1,0]
  v_pk_add_f32 v[240:241], v[240:241], 1.0 op_sel_hi:[1,0]
  v_pk_add_f32 v[242:243], v[242:243], 1.0 op_sel_hi:[1,0]
  v_rcp_f32 v68, v68
  v_rcp_f32 v69, v69
  v_rcp_f32 v70, v70
  v_rcp_f32 v71, v71
  v_rcp_f32 v72, v72
  v_rcp_f32 v73, v73
  v_rcp_f32 v74, v74
  v_rcp_f32 v75, v75
  v_rcp_f32 v76, v76
  v_rcp_f32 v77, v77
  v_rcp_f32 v78, v78
  v_rcp_f32 v79, v79
  v_rcp_f32 v240, v240
  v_rcp_f32 v241, v241
  v_rcp_f32 v242, v242
  v_rcp_f32 v243, v243
  v_pk_mul_f32 v[68:69], v[68:69], v[56:57]
  v_pk_mul_f32 v[70:71], v[70:71], v[58:59]
  v_pk_mul_f32 v[72:73], v[72:73], v[60:61]
  v_pk_mul_f32 v[74:75], v[74:75], v[62:63]
  v_pk_mul_f32 v[76:77], v[76:77], v[64:65]
  v_pk_mul_f32 v[78:79], v[78:79], v[66:67]
  v_pk_mul_f32 v[240:241], v[240:241], v[236:237]
  v_pk_mul_f32 v[242:243], v[242:243], v[238:239]
  v_pk_mul_f32 v[80:81], v[68:69], v[68:69]
  v_pk_mul_f32 v[82:83], v[70:71], v[70:71]
  v_pk_fma_f32 v[80:81], v[72:73], v[72:73], v[80:81]
  v_pk_fma_f32 v[82:83], v[74:75], v[74:75], v[82:83]
  v_pk_fma_f32 v[80:81], v[76:77], v[76:77], v[80:81]
  v_pk_fma_f32 v[82:83], v[78:79], v[78:79], v[82:83]
  v_pk_fma_f32 v[80:81], v[240:241], v[240:241], v[80:81]
  v_pk_fma_f32 v[82:83], v[242:243], v[242:243], v[82:83]
  v_cvt_pk_bf16_f32 v106, v68, v69
  v_cvt_pk_bf16_f32 v107, v70, v71
  v_cvt_pk_bf16_f32 v154, v72, v73
  v_cvt_pk_bf16_f32 v155, v74, v75
  v_cvt_pk_bf16_f32 v202, v76, v77
  v_cvt_pk_bf16_f32 v203, v78, v79
  v_cvt_pk_bf16_f32 v250, v240, v241
  v_cvt_pk_bf16_f32 v251, v242, v243
  v_pk_fma_f32 v[68:69], v[44:45], v[44:45], s[50:51]
  v_add_f32_dpp v84, v80, v80 row_ror:8 row_mask:0xf bank_mask:0x3
  v_add_f32_dpp v84, v81, v81 row_ror:8 row_mask:0xf bank_mask:0xc
  v_pk_fma_f32 v[70:71], v[46:47], v[46:47], s[50:51]
  v_add_f32_dpp v85, v82, v82 row_ror:8 row_mask:0xf bank_mask:0x3
  v_add_f32_dpp v85, v83, v83 row_ror:8 row_mask:0xf bank_mask:0xc
  v_pk_fma_f32 v[72:73], v[48:49], v[48:49], s[50:51]
  v_pk_fma_f32 v[74:75], v[50:51], v[50:51], s[50:51]
  v_add_f32_dpp v86, v84, v84 row_half_mirror row_mask:0xf bank_mask:0x5
  v_add_f32_dpp v86, v85, v85 row_half_mirror row_mask:0xf bank_mask:0xa
  v_pk_fma_f32 v[76:77], v[52:53], v[52:53], s[50:51]
  v_pk_fma_f32 v[78:79], v[54:55], v[54:55], s[50:51]
  v_pk_fma_f32 v[240:241], v[192:193], v[192:193], s[50:51]
  v_add_f32_dpp v86, v86, v86 quad_perm:[1,0,3,2] row_mask:0xf bank_mask:0xf
  v_pk_fma_f32 v[242:243], v[194:195], v[194:195], s[50:51]
  v_pk_mul_f32 v[68:69], v[68:69], v[44:45]
  v_pk_mul_f32 v[70:71], v[70:71], v[46:47]
  v_add_f32_dpp v86, v86, v86 quad_perm:[2,3,0,1] row_mask:0xf bank_mask:0xf
  v_pk_mul_f32 v[72:73], v[72:73], v[48:49]
  v_pk_mul_f32 v[74:75], v[74:75], v[50:51]
  v_cndmask_b32 v87, v87, v86, s[58:59]
  v_pk_mul_f32 v[76:77], v[76:77], v[52:53]
  v_pk_mul_f32 v[78:79], v[78:79], v[54:55]
  v_pk_mul_f32 v[240:241], v[240:241], v[192:193]
  v_pk_mul_f32 v[242:243], v[242:243], v[194:195]
  s_waitcnt lgkmcnt(0)
  v_mfma_f32_16x16x32_bf16 v[56:59], a[72:75], v[8:11], 0
  v_exp_f32 v68, v68
  v_mfma_f32_16x16x32_bf16 v[60:63], a[72:75], v[20:23], 0
  s_add_u32 m0, s77, 3072
  s_add_u32 s67, s76, 3072
  buffer_load_dwordx4 v93, s[36:39], s67 offen offset:0 lds
  v_exp_f32_e64 v69, v69
  v_mfma_f32_16x16x32_bf16 v[64:67], a[72:75], v[32:35], 0
  v_exp_f32_e64 v70, v70
  v_mfma_f32_16x16x32_bf16 v[236:239], a[72:75], v[140:143], 0
  v_exp_f32_e64 v71, v71
  v_mfma_f32_16x16x32_bf16 v[56:59], a[76:79], v[12:15], v[56:59]
  v_exp_f32_e64 v72, v72
  v_mfma_f32_16x16x32_bf16 v[60:63], a[76:79], v[24:27], v[60:63]
  v_exp_f32_e64 v73, v73
  v_mfma_f32_16x16x32_bf16 v[64:67], a[76:79], v[36:39], v[64:67]
  v_exp_f32_e64 v74, v74
  v_mfma_f32_16x16x32_bf16 v[236:239], a[76:79], v[144:147], v[236:239]
  v_exp_f32_e64 v75, v75
  v_mfma_f32_16x16x32_bf16 v[56:59], a[80:83], v[16:19], v[56:59]
  v_exp_f32_e64 v76, v76
  v_mfma_f32_16x16x32_bf16 v[60:63], a[80:83], v[28:31], v[60:63]
  v_exp_f32_e64 v77, v77
  v_mfma_f32_16x16x32_bf16 v[64:67], a[80:83], v[40:43], v[64:67]
  v_exp_f32_e64 v78, v78
  v_mfma_f32_16x16x32_bf16 v[236:239], a[80:83], v[188:191], v[236:239]
  s_add_u32 s66, s44, 1
  s_and_b32 s66, s66, 3
  s_mul_i32 s66, s66, 192
  v_add_u32_e64 v4, s66, v6
  ds_read_b64_tr_b16 a[72:73], v4 offset:0
  ds_read_b64_tr_b16 a[74:75], v4 offset:12800
  ds_read_b64_tr_b16 a[76:77], v4 offset:25600
  ds_read_b64_tr_b16 a[78:79], v4 offset:38400
  ds_read_b64_tr_b16 a[80:81], v4 offset:51200
  ds_read_b64_tr_b16 a[82:83], v4 offset:64000
  v_exp_f32 v79, v79
  v_exp_f32 v240, v240
  v_exp_f32 v241, v241
  v_exp_f32 v242, v242
  v_exp_f32_e64 v243, v243
  v_pk_add_f32 v[68:69], v[68:69], 1.0 op_sel_hi:[1,0]
  v_pk_add_f32 v[70:71], v[70:71], 1.0 op_sel_hi:[1,0]
  v_pk_add_f32 v[72:73], v[72:73], 1.0 op_sel_hi:[1,0]
  v_pk_add_f32 v[74:75], v[74:75], 1.0 op_sel_hi:[1,0]
  v_pk_add_f32 v[76:77], v[76:77], 1.0 op_sel_hi:[1,0]
  v_pk_add_f32 v[78:79], v[78:79], 1.0 op_sel_hi:[1,0]
  v_pk_add_f32 v[240:241], v[240:241], 1.0 op_sel_hi:[1,0]
  v_pk_add_f32 v[242:243], v[242:243], 1.0 op_sel_hi:[1,0]
  v_rcp_f32 v68, v68
  v_rcp_f32 v69, v69
  v_rcp_f32 v70, v70
  v_rcp_f32 v71, v71
  v_rcp_f32 v72, v72
  v_rcp_f32 v73, v73
  v_rcp_f32 v74, v74
  v_rcp_f32 v75, v75
  v_rcp_f32 v76, v76
  v_rcp_f32 v77, v77
  v_rcp_f32 v78, v78
  v_rcp_f32 v79, v79
  v_rcp_f32 v240, v240
  v_rcp_f32 v241, v241
  v_rcp_f32 v242, v242
  v_rcp_f32 v243, v243
  v_pk_mul_f32 v[68:69], v[68:69], v[44:45]
  v_pk_mul_f32 v[70:71], v[70:71], v[46:47]
  v_pk_mul_f32 v[72:73], v[72:73], v[48:49]
  v_pk_mul_f32 v[74:75], v[74:75], v[50:51]
  v_pk_mul_f32 v[76:77], v[76:77], v[52:53]
  v_pk_mul_f32 v[78:79], v[78:79], v[54:55]
  v_pk_mul_f32 v[240:241], v[240:241], v[192:193]
  v_pk_mul_f32 v[242:243], v[242:243], v[194:195]
  v_pk_mul_f32 v[80:81], v[68:69], v[68:69]
  v_pk_mul_f32 v[82:83], v[70:71], v[70:71]
  v_pk_fma_f32 v[80:81], v[72:73], v[72:73], v[80:81]
  v_pk_fma_f32 v[82:83], v[74:75], v[74:75], v[82:83]
  v_pk_fma_f32 v[80:81], v[76:77], v[76:77], v[80:81]
  v_pk_fma_f32 v[82:83], v[78:79], v[78:79], v[82:83]
  v_pk_fma_f32 v[80:81], v[240:241], v[240:241], v[80:81]
  v_pk_fma_f32 v[82:83], v[242:243], v[242:243], v[82:83]
  v_cvt_pk_bf16_f32 v108, v68, v69
  v_cvt_pk_bf16_f32 v109, v70, v71
  v_cvt_pk_bf16_f32 v156, v72, v73
  v_cvt_pk_bf16_f32 v157, v74, v75
  v_cvt_pk_bf16_f32 v204, v76, v77
  v_cvt_pk_bf16_f32 v205, v78, v79
  v_cvt_pk_bf16_f32 v252, v240, v241
  v_cvt_pk_bf16_f32 v253, v242, v243
  v_pk_fma_f32 v[68:69], v[56:57], v[56:57], s[50:51]
  v_add_f32_dpp v84, v80, v80 row_ror:8 row_mask:0xf bank_mask:0x3
  v_add_f32_dpp v84, v81, v81 row_ror:8 row_mask:0xf bank_mask:0xc
  v_pk_fma_f32 v[70:71], v[58:59], v[58:59], s[50:51]
  v_add_f32_dpp v85, v82, v82 row_ror:8 row_mask:0xf bank_mask:0x3
  v_add_f32_dpp v85, v83, v83 row_ror:8 row_mask:0xf bank_mask:0xc
  v_pk_fma_f32 v[72:73], v[60:61], v[60:61], s[50:51]
  v_pk_fma_f32 v[74:75], v[62:63], v[62:63], s[50:51]
  v_add_f32_dpp v86, v84, v84 row_half_mirror row_mask:0xf bank_mask:0x5
  v_add_f32_dpp v86, v85, v85 row_half_mirror row_mask:0xf bank_mask:0xa
  v_pk_fma_f32 v[76:77], v[64:65], v[64:65], s[50:51]
  v_pk_fma_f32 v[78:79], v[66:67], v[66:67], s[50:51]
  v_pk_fma_f32 v[240:241], v[236:237], v[236:237], s[50:51]
  v_add_f32_dpp v86, v86, v86 quad_perm:[1,0,3,2] row_mask:0xf bank_mask:0xf
  v_pk_fma_f32 v[242:243], v[238:239], v[238:239], s[50:51]
  v_pk_mul_f32 v[68:69], v[68:69], v[56:57]
  v_pk_mul_f32 v[70:71], v[70:71], v[58:59]
  v_add_f32_dpp v86, v86, v86 quad_perm:[2,3,0,1] row_mask:0xf bank_mask:0xf
  v_pk_mul_f32 v[72:73], v[72:73], v[60:61]
  v_pk_mul_f32 v[74:75], v[74:75], v[62:63]
  v_cndmask_b32 v88, v88, v86, s[52:53]
  v_pk_mul_f32 v[76:77], v[76:77], v[64:65]
  v_pk_mul_f32 v[78:79], v[78:79], v[66:67]
  v_pk_mul_f32 v[240:241], v[240:241], v[236:237]
  v_pk_mul_f32 v[242:243], v[242:243], v[238:239]
  s_waitcnt lgkmcnt(0)
  v_mfma_f32_16x16x32_bf16 v[44:47], a[72:75], v[8:11], 0
  v_exp_f32 v68, v68
  v_mfma_f32_16x16x32_bf16 v[48:51], a[72:75], v[20:23], 0
  buffer_load_dwordx4 v94, s[36:39], s67 offen offset:1024 lds
  v_exp_f32_e64 v69, v69
  v_mfma_f32_16x16x32_bf16 v[52:55], a[72:75], v[32:35], 0
  v_exp_f32_e64 v70, v70
  v_mfma_f32_16x16x32_bf16 v[44:47], a[76:79], v[12:15], v[44:47]
  v_exp_f32_e64 v71, v71
  v_mfma_f32_16x16x32_bf16 v[48:51], a[76:79], v[24:27], v[48:51]
  v_exp_f32_e64 v72, v72
  v_mfma_f32_16x16x32_bf16 v[52:55], a[76:79], v[36:39], v[52:55]
  v_exp_f32_e64 v73, v73
  v_mfma_f32_16x16x32_bf16 v[44:47], a[80:83], v[16:19], v[44:47]
  v_exp_f32_e64 v74, v74
  v_mfma_f32_16x16x32_bf16 v[48:51], a[80:83], v[28:31], v[48:51]
  v_exp_f32_e64 v75, v75
  v_mfma_f32_16x16x32_bf16 v[52:55], a[80:83], v[40:43], v[52:55]
  ds_read_b64_tr_b16 a[72:73], v4 offset:32
  ds_read_b64_tr_b16 a[74:75], v4 offset:12832
  ds_read_b64_tr_b16 a[76:77], v4 offset:25632
  ds_read_b64_tr_b16 a[78:79], v4 offset:38432
  ds_read_b64_tr_b16 a[80:81], v4 offset:51232
  ds_read_b64_tr_b16 a[82:83], v4 offset:64032
  v_exp_f32 v76, v76
  v_exp_f32 v77, v77
  v_exp_f32 v78, v78
  v_exp_f32 v79, v79
  v_exp_f32 v240, v240
  v_exp_f32 v241, v241
  v_exp_f32 v242, v242
  v_exp_f32 v243, v243
  v_pk_add_f32 v[68:69], v[68:69], 1.0 op_sel_hi:[1,0]
  v_pk_add_f32 v[70:71], v[70:71], 1.0 op_sel_hi:[1,0]
  v_pk_add_f32 v[72:73], v[72:73], 1.0 op_sel_hi:[1,0]
  v_pk_add_f32 v[74:75], v[74:75], 1.0 op_sel_hi:[1,0]
  v_pk_add_f32 v[76:77], v[76:77], 1.0 op_sel_hi:[1,0]
  v_pk_add_f32 v[78:79], v[78:79], 1.0 op_sel_hi:[1,0]
  v_pk_add_f32 v[240:241], v[240:241], 1.0 op_sel_hi:[1,0]
  v_pk_add_f32 v[242:243], v[242:243], 1.0 op_sel_hi:[1,0]
  v_rcp_f32 v68, v68
  v_rcp_f32 v69, v69
  v_rcp_f32 v70, v70
  v_rcp_f32 v71, v71
  v_rcp_f32 v72, v72
  v_rcp_f32 v73, v73
  v_rcp_f32 v74, v74
  v_rcp_f32 v75, v75
  v_rcp_f32 v76, v76
  v_rcp_f32 v77, v77
  v_rcp_f32 v78, v78
  v_rcp_f32 v79, v79
  v_rcp_f32 v240, v240
  v_rcp_f32 v241, v241
  v_rcp_f32 v242, v242
  v_rcp_f32 v243, v243
  v_pk_mul_f32 v[68:69], v[68:69], v[56:57]
  v_pk_mul_f32 v[70:71], v[70:71], v[58:59]
  v_pk_mul_f32 v[72:73], v[72:73], v[60:61]
  v_pk_mul_f32 v[74:75], v[74:75], v[62:63]
  v_pk_mul_f32 v[76:77], v[76:77], v[64:65]
  v_pk_mul_f32 v[78:79], v[78:79], v[66:67]
  v_pk_mul_f32 v[240:241], v[240:241], v[236:237]
  v_pk_mul_f32 v[242:243], v[242:243], v[238:239]
  v_pk_mul_f32 v[80:81], v[68:69], v[68:69]
  v_pk_mul_f32 v[82:83], v[70:71], v[70:71]
  v_pk_fma_f32 v[80:81], v[72:73], v[72:73], v[80:81]
  v_pk_fma_f32 v[82:83], v[74:75], v[74:75], v[82:83]
  v_pk_fma_f32 v[80:81], v[76:77], v[76:77], v[80:81]
  v_pk_fma_f32 v[82:83], v[78:79], v[78:79], v[82:83]
  v_pk_fma_f32 v[80:81], v[240:241], v[240:241], v[80:81]
  v_pk_fma_f32 v[82:83], v[242:243], v[242:243], v[82:83]
  v_cvt_pk_bf16_f32 v110, v68, v69
  v_cvt_pk_bf16_f32 v111, v70, v71
  v_cvt_pk_bf16_f32 v158, v72, v73
  v_cvt_pk_bf16_f32 v159, v74, v75
  v_cvt_pk_bf16_f32 v206, v76, v77
  v_cvt_pk_bf16_f32 v207, v78, v79
  v_cvt_pk_bf16_f32 v254, v240, v241
  v_cvt_pk_bf16_f32 v255, v242, v243
  v_pk_fma_f32 v[68:69], v[44:45], v[44:45], s[50:51]
  v_add_f32_dpp v84, v80, v80 row_ror:8 row_mask:0xf bank_mask:0x3
  v_add_f32_dpp v84, v81, v81 row_ror:8 row_mask:0xf bank_mask:0xc
  v_pk_fma_f32 v[70:71], v[46:47], v[46:47], s[50:51]
  v_add_f32_dpp v85, v82, v82 row_ror:8 row_mask:0xf bank_mask:0x3
  v_add_f32_dpp v85, v83, v83 row_ror:8 row_mask:0xf bank_mask:0xc
  v_pk_fma_f32 v[72:73], v[48:49], v[48:49], s[50:51]
  v_pk_fma_f32 v[74:75], v[50:51], v[50:51], s[50:51]
  v_add_f32_dpp v86, v84, v84 row_half_mirror row_mask:0xf bank_mask:0x5
  v_add_f32_dpp v86, v85, v85 row_half_mirror row_mask:0xf bank_mask:0xa
  v_pk_fma_f32 v[76:77], v[52:53], v[52:53], s[50:51]
  v_pk_fma_f32 v[78:79], v[54:55], v[54:55], s[50:51]
  v_pk_mul_f32 v[68:69], v[68:69], v[44:45]
  v_add_f32_dpp v86, v86, v86 quad_perm:[1,0,3,2] row_mask:0xf bank_mask:0xf
  v_pk_mul_f32 v[70:71], v[70:71], v[46:47]
  v_pk_mul_f32 v[72:73], v[72:73], v[48:49]
  v_pk_mul_f32 v[74:75], v[74:75], v[50:51]
  v_add_f32_dpp v86, v86, v86 quad_perm:[2,3,0,1] row_mask:0xf bank_mask:0xf
  v_pk_mul_f32 v[76:77], v[76:77], v[52:53]
  v_pk_mul_f32 v[78:79], v[78:79], v[54:55]
  v_cndmask_b32 v88, v88, v86, s[54:55]
  s_waitcnt lgkmcnt(0)
  v_mfma_f32_16x16x32_bf16 v[56:59], a[72:75], v[8:11], 0
  v_exp_f32 v68, v68
  v_mfma_f32_16x16x32_bf16 v[60:63], a[72:75], v[20:23], 0
  buffer_load_dwordx4 v95, s[36:39], s67 offen offset:2048 lds
  v_exp_f32_e64 v69, v69
  v_mfma_f32_16x16x32_bf16 v[64:67], a[72:75], v[32:35], 0
  v_exp_f32_e64 v70, v70
  v_mfma_f32_16x16x32_bf16 v[56:59], a[76:79], v[12:15], v[56:59]
  v_exp_f32_e64 v71, v71
  v_mfma_f32_16x16x32_bf16 v[60:63], a[76:79], v[24:27], v[60:63]
  v_exp_f32_e64 v72, v72
  v_mfma_f32_16x16x32_bf16 v[64:67], a[76:79], v[36:39], v[64:67]
  v_exp_f32_e64 v73, v73
  v_mfma_f32_16x16x32_bf16 v[56:59], a[80:83], v[16:19], v[56:59]
  v_exp_f32_e64 v74, v74
  v_mfma_f32_16x16x32_bf16 v[60:63], a[80:83], v[28:31], v[60:63]
  v_exp_f32_e64 v75, v75
  v_mfma_f32_16x16x32_bf16 v[64:67], a[80:83], v[40:43], v[64:67]
  ds_read_b64_tr_b16 a[72:73], v4 offset:64
  ds_read_b64_tr_b16 a[74:75], v4 offset:12864
  ds_read_b64_tr_b16 a[76:77], v4 offset:25664
  ds_read_b64_tr_b16 a[78:79], v4 offset:38464
  ds_read_b64_tr_b16 a[80:81], v4 offset:51264
  ds_read_b64_tr_b16 a[82:83], v4 offset:64064
  v_exp_f32 v76, v76
  v_exp_f32 v77, v77
  v_exp_f32 v78, v78
  v_exp_f32 v79, v79
  v_pk_add_f32 v[68:69], v[68:69], 1.0 op_sel_hi:[1,0]
  v_pk_add_f32 v[70:71], v[70:71], 1.0 op_sel_hi:[1,0]
  v_pk_add_f32 v[72:73], v[72:73], 1.0 op_sel_hi:[1,0]
  v_pk_add_f32 v[74:75], v[74:75], 1.0 op_sel_hi:[1,0]
  v_pk_add_f32 v[76:77], v[76:77], 1.0 op_sel_hi:[1,0]
  v_pk_add_f32 v[78:79], v[78:79], 1.0 op_sel_hi:[1,0]
  v_rcp_f32 v68, v68
  v_rcp_f32 v69, v69
  v_rcp_f32 v70, v70
  v_rcp_f32 v71, v71
  v_rcp_f32 v72, v72
  v_rcp_f32 v73, v73
  v_rcp_f32 v74, v74
  v_rcp_f32 v75, v75
  v_rcp_f32 v76, v76
  v_rcp_f32 v77, v77
  v_rcp_f32 v78, v78
  v_rcp_f32 v79, v79
  v_pk_mul_f32 v[68:69], v[68:69], v[44:45]
  v_pk_mul_f32 v[70:71], v[70:71], v[46:47]
  v_pk_mul_f32 v[72:73], v[72:73], v[48:49]
  v_pk_mul_f32 v[74:75], v[74:75], v[50:51]
  v_pk_mul_f32 v[76:77], v[76:77], v[52:53]
  v_pk_mul_f32 v[78:79], v[78:79], v[54:55]
  v_pk_mul_f32 v[80:81], v[68:69], v[68:69]
  v_pk_mul_f32 v[82:83], v[70:71], v[70:71]
  v_pk_fma_f32 v[80:81], v[72:73], v[72:73], v[80:81]
  v_pk_fma_f32 v[82:83], v[74:75], v[74:75], v[82:83]
  v_pk_fma_f32 v[80:81], v[76:77], v[76:77], v[80:81]
  v_pk_fma_f32 v[82:83], v[78:79], v[78:79], v[82:83]
  v_cvt_pk_bf16_f32 v112, v68, v69
  v_cvt_pk_bf16_f32 v113, v70, v71
  v_cvt_pk_bf16_f32 v160, v72, v73
  v_cvt_pk_bf16_f32 v161, v74, v75
  v_cvt_pk_bf16_f32 v208, v76, v77
  v_cvt_pk_bf16_f32 v209, v78, v79
  v_pk_fma_f32 v[68:69], v[56:57], v[56:57], s[50:51]
  v_add_f32_dpp v84, v80, v80 row_ror:8 row_mask:0xf bank_mask:0x3
  v_add_f32_dpp v84, v81, v81 row_ror:8 row_mask:0xf bank_mask:0xc
  v_pk_fma_f32 v[70:71], v[58:59], v[58:59], s[50:51]
  v_add_f32_dpp v85, v82, v82 row_ror:8 row_mask:0xf bank_mask:0x3
  v_add_f32_dpp v85, v83, v83 row_ror:8 row_mask:0xf bank_mask:0xc
  v_pk_fma_f32 v[72:73], v[60:61], v[60:61], s[50:51]
  v_pk_fma_f32 v[74:75], v[62:63], v[62:63], s[50:51]
  v_add_f32_dpp v86, v84, v84 row_half_mirror row_mask:0xf bank_mask:0x5
  v_add_f32_dpp v86, v85, v85 row_half_mirror row_mask:0xf bank_mask:0xa
  v_pk_fma_f32 v[76:77], v[64:65], v[64:65], s[50:51]
  v_pk_fma_f32 v[78:79], v[66:67], v[66:67], s[50:51]
  v_pk_mul_f32 v[68:69], v[68:69], v[56:57]
  v_add_f32_dpp v86, v86, v86 quad_perm:[1,0,3,2] row_mask:0xf bank_mask:0xf
  v_pk_mul_f32 v[70:71], v[70:71], v[58:59]
  v_pk_mul_f32 v[72:73], v[72:73], v[60:61]
  v_pk_mul_f32 v[74:75], v[74:75], v[62:63]
  v_add_f32_dpp v86, v86, v86 quad_perm:[2,3,0,1] row_mask:0xf bank_mask:0xf
  v_pk_mul_f32 v[76:77], v[76:77], v[64:65]
  v_pk_mul_f32 v[78:79], v[78:79], v[66:67]
  v_cndmask_b32 v88, v88, v86, s[56:57]
  s_waitcnt lgkmcnt(0)
  v_mfma_f32_16x16x32_bf16 v[44:47], a[72:75], v[8:11], 0
  v_exp_f32 v68, v68
  v_mfma_f32_16x16x32_bf16 v[48:51], a[72:75], v[20:23], 0
  s_add_u32 m0, s77, 6144
  s_add_u32 s67, s76, 6144
  buffer_load_dwordx4 v93, s[36:39], s67 offen offset:0 lds
  v_exp_f32_e64 v69, v69
  v_mfma_f32_16x16x32_bf16 v[52:55], a[72:75], v[32:35], 0
  v_exp_f32_e64 v70, v70
  v_mfma_f32_16x16x32_bf16 v[44:47], a[76:79], v[12:15], v[44:47]
  v_exp_f32_e64 v71, v71
  v_mfma_f32_16x16x32_bf16 v[48:51], a[76:79], v[24:27], v[48:51]
  v_exp_f32_e64 v72, v72
  v_mfma_f32_16x16x32_bf16 v[52:55], a[76:79], v[36:39], v[52:55]
  v_exp_f32_e64 v73, v73
  v_mfma_f32_16x16x32_bf16 v[44:47], a[80:83], v[16:19], v[44:47]
  v_exp_f32_e64 v74, v74
  v_mfma_f32_16x16x32_bf16 v[48:51], a[80:83], v[28:31], v[48:51]
  v_exp_f32_e64 v75, v75
  v_mfma_f32_16x16x32_bf16 v[52:55], a[80:83], v[40:43], v[52:55]
  ds_read_b64_tr_b16 a[72:73], v4 offset:96
  ds_read_b64_tr_b16 a[74:75], v4 offset:12896
  ds_read_b64_tr_b16 a[76:77], v4 offset:25696
  ds_read_b64_tr_b16 a[78:79], v4 offset:38496
  ds_read_b64_tr_b16 a[80:81], v4 offset:51296
  ds_read_b64_tr_b16 a[82:83], v4 offset:64096
  v_exp_f32 v76, v76
  v_exp_f32 v77, v77
  v_exp_f32 v78, v78
  v_exp_f32 v79, v79
  v_pk_add_f32 v[68:69], v[68:69], 1.0 op_sel_hi:[1,0]
  v_pk_add_f32 v[70:71], v[70:71], 1.0 op_sel_hi:[1,0]
  v_pk_add_f32 v[72:73], v[72:73], 1.0 op_sel_hi:[1,0]
  v_pk_add_f32 v[74:75], v[74:75], 1.0 op_sel_hi:[1,0]
  v_pk_add_f32 v[76:77], v[76:77], 1.0 op_sel_hi:[1,0]
  v_pk_add_f32 v[78:79], v[78:79], 1.0 op_sel_hi:[1,0]
  v_rcp_f32 v68, v68
  v_rcp_f32 v69, v69
  v_rcp_f32 v70, v70
  v_rcp_f32 v71, v71
  v_rcp_f32 v72, v72
  v_rcp_f32 v73, v73
  v_rcp_f32 v74, v74
  v_rcp_f32 v75, v75
  v_rcp_f32 v76, v76
  v_rcp_f32 v77, v77
  v_rcp_f32 v78, v78
  v_rcp_f32 v79, v79
  v_pk_mul_f32 v[68:69], v[68:69], v[56:57]
  v_pk_mul_f32 v[70:71], v[70:71], v[58:59]
  v_pk_mul_f32 v[72:73], v[72:73], v[60:61]
  v_pk_mul_f32 v[74:75], v[74:75], v[62:63]
  v_pk_mul_f32 v[76:77], v[76:77], v[64:65]
  v_pk_mul_f32 v[78:79], v[78:79], v[66:67]
  v_pk_mul_f32 v[80:81], v[68:69], v[68:69]
  v_pk_mul_f32 v[82:83], v[70:71], v[70:71]
  v_pk_fma_f32 v[80:81], v[72:73], v[72:73], v[80:81]
  v_pk_fma_f32 v[82:83], v[74:75], v[74:75], v[82:83]
  v_pk_fma_f32 v[80:81], v[76:77], v[76:77], v[80:81]
  v_pk_fma_f32 v[82:83], v[78:79], v[78:79], v[82:83]
  v_cvt_pk_bf16_f32 v114, v68, v69
  v_cvt_pk_bf16_f32 v115, v70, v71
  v_cvt_pk_bf16_f32 v162, v72, v73
  v_cvt_pk_bf16_f32 v163, v74, v75
  v_cvt_pk_bf16_f32 v210, v76, v77
  v_cvt_pk_bf16_f32 v211, v78, v79
  v_pk_fma_f32 v[68:69], v[44:45], v[44:45], s[50:51]
  v_add_f32_dpp v84, v80, v80 row_ror:8 row_mask:0xf bank_mask:0x3
  v_add_f32_dpp v84, v81, v81 row_ror:8 row_mask:0xf bank_mask:0xc
  v_pk_fma_f32 v[70:71], v[46:47], v[46:47], s[50:51]
  v_add_f32_dpp v85, v82, v82 row_ror:8 row_mask:0xf bank_mask:0x3
  v_add_f32_dpp v85, v83, v83 row_ror:8 row_mask:0xf bank_mask:0xc
  v_pk_fma_f32 v[72:73], v[48:49], v[48:49], s[50:51]
  v_pk_fma_f32 v[74:75], v[50:51], v[50:51], s[50:51]
  v_add_f32_dpp v86, v84, v84 row_half_mirror row_mask:0xf bank_mask:0x5
  v_add_f32_dpp v86, v85, v85 row_half_mirror row_mask:0xf bank_mask:0xa
  v_pk_fma_f32 v[76:77], v[52:53], v[52:53], s[50:51]
  v_pk_fma_f32 v[78:79], v[54:55], v[54:55], s[50:51]
  v_pk_mul_f32 v[68:69], v[68:69], v[44:45]
  v_add_f32_dpp v86, v86, v86 quad_perm:[1,0,3,2] row_mask:0xf bank_mask:0xf
  v_pk_mul_f32 v[70:71], v[70:71], v[46:47]
  v_pk_mul_f32 v[72:73], v[72:73], v[48:49]
  v_pk_mul_f32 v[74:75], v[74:75], v[50:51]
  v_add_f32_dpp v86, v86, v86 quad_perm:[2,3,0,1] row_mask:0xf bank_mask:0xf
  v_pk_mul_f32 v[76:77], v[76:77], v[52:53]
  v_pk_mul_f32 v[78:79], v[78:79], v[54:55]
  v_cndmask_b32 v88, v88, v86, s[58:59]
  s_waitcnt lgkmcnt(0)
  v_mfma_f32_16x16x32_bf16 v[56:59], a[72:75], v[8:11], 0
  v_exp_f32 v68, v68
  v_mfma_f32_16x16x32_bf16 v[60:63], a[72:75], v[20:23], 0
  buffer_load_dwordx4 v94, s[36:39], s67 offen offset:1024 lds
  v_exp_f32_e64 v69, v69
  v_mfma_f32_16x16x32_bf16 v[64:67], a[72:75], v[32:35], 0
  v_exp_f32_e64 v70, v70
  v_mfma_f32_16x16x32_bf16 v[56:59], a[76:79], v[12:15], v[56:59]
  v_exp_f32_e64 v71, v71
  v_mfma_f32_16x16x32_bf16 v[60:63], a[76:79], v[24:27], v[60:63]
  v_exp_f32_e64 v72, v72
  v_mfma_f32_16x16x32_bf16 v[64:67], a[76:79], v[36:39], v[64:67]
  v_exp_f32_e64 v73, v73
  v_mfma_f32_16x16x32_bf16 v[56:59], a[80:83], v[16:19], v[56:59]
  v_exp_f32_e64 v74, v74
  v_mfma_f32_16x16x32_bf16 v[60:63], a[80:83], v[28:31], v[60:63]
  v_exp_f32_e64 v75, v75
  v_mfma_f32_16x16x32_bf16 v[64:67], a[80:83], v[40:43], v[64:67]
  ds_read_b64_tr_b16 a[72:73], v4 offset:128
  ds_read_b64_tr_b16 a[74:75], v4 offset:12928
  ds_read_b64_tr_b16 a[76:77], v4 offset:25728
  ds_read_b64_tr_b16 a[78:79], v4 offset:38528
  ds_read_b64_tr_b16 a[80:81], v4 offset:51328
  ds_read_b64_tr_b16 a[82:83], v4 offset:64128
  v_exp_f32 v76, v76
  v_exp_f32 v77, v77
  v_exp_f32 v78, v78
  v_exp_f32 v79, v79
  v_pk_add_f32 v[68:69], v[68:69], 1.0 op_sel_hi:[1,0]
  v_pk_add_f32 v[70:71], v[70:71], 1.0 op_sel_hi:[1,0]
  v_pk_add_f32 v[72:73], v[72:73], 1.0 op_sel_hi:[1,0]
  v_pk_add_f32 v[74:75], v[74:75], 1.0 op_sel_hi:[1,0]
  v_pk_add_f32 v[76:77], v[76:77], 1.0 op_sel_hi:[1,0]
  v_pk_add_f32 v[78:79], v[78:79], 1.0 op_sel_hi:[1,0]
  v_rcp_f32 v68, v68
  v_rcp_f32 v69, v69
  v_rcp_f32 v70, v70
  v_rcp_f32 v71, v71
  v_rcp_f32 v72, v72
  v_rcp_f32 v73, v73
  v_rcp_f32 v74, v74
  v_rcp_f32 v75, v75
  v_rcp_f32 v76, v76
  v_rcp_f32 v77, v77
  v_rcp_f32 v78, v78
  v_rcp_f32 v79, v79
  v_pk_mul_f32 v[68:69], v[68:69], v[44:45]
  v_pk_mul_f32 v[70:71], v[70:71], v[46:47]
  v_pk_mul_f32 v[72:73], v[72:73], v[48:49]
  v_pk_mul_f32 v[74:75], v[74:75], v[50:51]
  v_pk_mul_f32 v[76:77], v[76:77], v[52:53]
  v_pk_mul_f32 v[78:79], v[78:79], v[54:55]
  v_pk_mul_f32 v[80:81], v[68:69], v[68:69]
  v_pk_mul_f32 v[82:83], v[70:71], v[70:71]
  v_pk_fma_f32 v[80:81], v[72:73], v[72:73], v[80:81]
  v_pk_fma_f32 v[82:83], v[74:75], v[74:75], v[82:83]
  v_pk_fma_f32 v[80:81], v[76:77], v[76:77], v[80:81]
  v_pk_fma_f32 v[82:83], v[78:79], v[78:79], v[82:83]
  v_cvt_pk_bf16_f32 v116, v68, v69
  v_cvt_pk_bf16_f32 v117, v70, v71
  v_cvt_pk_bf16_f32 v164, v72, v73
  v_cvt_pk_bf16_f32 v165, v74, v75
  v_cvt_pk_bf16_f32 v212, v76, v77
  v_cvt_pk_bf16_f32 v213, v78, v79
  v_pk_fma_f32 v[68:69], v[56:57], v[56:57], s[50:51]
  v_add_f32_dpp v84, v80, v80 row_ror:8 row_mask:0xf bank_mask:0x3
  v_add_f32_dpp v84, v81, v81 row_ror:8 row_mask:0xf bank_mask:0xc
  v_pk_fma_f32 v[70:71], v[58:59], v[58:59], s[50:51]
  v_add_f32_dpp v85, v82, v82 row_ror:8 row_mask:0xf bank_mask:0x3
  v_add_f32_dpp v85, v83, v83 row_ror:8 row_mask:0xf bank_mask:0xc
  v_pk_fma_f32 v[72:73], v[60:61], v[60:61], s[50:51]
  v_pk_fma_f32 v[74:75], v[62:63], v[62:63], s[50:51]
  v_add_f32_dpp v86, v84, v84 row_half_mirror row_mask:0xf bank_mask:0x5
  v_add_f32_dpp v86, v85, v85 row_half_mirror row_mask:0xf bank_mask:0xa
  v_pk_fma_f32 v[76:77], v[64:65], v[64:65], s[50:51]
  v_pk_fma_f32 v[78:79], v[66:67], v[66:67], s[50:51]
  v_pk_mul_f32 v[68:69], v[68:69], v[56:57]
  v_add_f32_dpp v86, v86, v86 quad_perm:[1,0,3,2] row_mask:0xf bank_mask:0xf
  v_pk_mul_f32 v[70:71], v[70:71], v[58:59]
  v_pk_mul_f32 v[72:73], v[72:73], v[60:61]
  v_pk_mul_f32 v[74:75], v[74:75], v[62:63]
  v_add_f32_dpp v86, v86, v86 quad_perm:[2,3,0,1] row_mask:0xf bank_mask:0xf
  v_pk_mul_f32 v[76:77], v[76:77], v[64:65]
  v_pk_mul_f32 v[78:79], v[78:79], v[66:67]
  v_cndmask_b32 v89, v89, v86, s[52:53]
  s_waitcnt lgkmcnt(0)
  v_mfma_f32_16x16x32_bf16 v[44:47], a[72:75], v[8:11], 0
  v_exp_f32 v68, v68
  v_mfma_f32_16x16x32_bf16 v[48:51], a[72:75], v[20:23], 0
  buffer_load_dwordx4 v95, s[36:39], s67 offen offset:2048 lds
  v_exp_f32_e64 v69, v69
  v_mfma_f32_16x16x32_bf16 v[52:55], a[72:75], v[32:35], 0
  v_exp_f32_e64 v70, v70
  v_mfma_f32_16x16x32_bf16 v[44:47], a[76:79], v[12:15], v[44:47]
  v_exp_f32_e64 v71, v71
  v_mfma_f32_16x16x32_bf16 v[48:51], a[76:79], v[24:27], v[48:51]
  v_exp_f32_e64 v72, v72
  v_mfma_f32_16x16x32_bf16 v[52:55], a[76:79], v[36:39], v[52:55]
  v_exp_f32_e64 v73, v73
  v_mfma_f32_16x16x32_bf16 v[44:47], a[80:83], v[16:19], v[44:47]
  v_exp_f32_e64 v74, v74
  v_mfma_f32_16x16x32_bf16 v[48:51], a[80:83], v[28:31], v[48:51]
  v_exp_f32_e64 v75, v75
  v_mfma_f32_16x16x32_bf16 v[52:55], a[80:83], v[40:43], v[52:55]
  ds_read_b64_tr_b16 a[72:73], v4 offset:160
  ds_read_b64_tr_b16 a[74:75], v4 offset:12960
  ds_read_b64_tr_b16 a[76:77], v4 offset:25760
  ds_read_b64_tr_b16 a[78:79], v4 offset:38560
  ds_read_b64_tr_b16 a[80:81], v4 offset:51360
  ds_read_b64_tr_b16 a[82:83], v4 offset:64160
  v_exp_f32 v76, v76
  v_exp_f32 v77, v77
  v_exp_f32 v78, v78
  v_exp_f32 v79, v79
  v_pk_add_f32 v[68:69], v[68:69], 1.0 op_sel_hi:[1,0]
  v_pk_add_f32 v[70:71], v[70:71], 1.0 op_sel_hi:[1,0]
  v_pk_add_f32 v[72:73], v[72:73], 1.0 op_sel_hi:[1,0]
  v_pk_add_f32 v[74:75], v[74:75], 1.0 op_sel_hi:[1,0]
  v_pk_add_f32 v[76:77], v[76:77], 1.0 op_sel_hi:[1,0]
  v_pk_add_f32 v[78:79], v[78:79], 1.0 op_sel_hi:[1,0]
  v_rcp_f32 v68, v68
  v_rcp_f32 v69, v69
  v_rcp_f32 v70, v70
  v_rcp_f32 v71, v71
  v_rcp_f32 v72, v72
  v_rcp_f32 v73, v73
  v_rcp_f32 v74, v74
  v_rcp_f32 v75, v75
  v_rcp_f32 v76, v76
  v_rcp_f32 v77, v77
  v_rcp_f32 v78, v78
  v_rcp_f32 v79, v79
  v_pk_mul_f32 v[68:69], v[68:69], v[56:57]
  v_pk_mul_f32 v[70:71], v[70:71], v[58:59]
  v_pk_mul_f32 v[72:73], v[72:73], v[60:61]
  v_pk_mul_f32 v[74:75], v[74:75], v[62:63]
  v_pk_mul_f32 v[76:77], v[76:77], v[64:65]
  v_pk_mul_f32 v[78:79], v[78:79], v[66:67]
  v_pk_mul_f32 v[80:81], v[68:69], v[68:69]
  v_pk_mul_f32 v[82:83], v[70:71], v[70:71]
  v_pk_fma_f32 v[80:81], v[72:73], v[72:73], v[80:81]
  v_pk_fma_f32 v[82:83], v[74:75], v[74:75], v[82:83]
  v_pk_fma_f32 v[80:81], v[76:77], v[76:77], v[80:81]
  v_pk_fma_f32 v[82:83], v[78:79], v[78:79], v[82:83]
  v_cvt_pk_bf16_f32 v118, v68, v69
  v_cvt_pk_bf16_f32 v119, v70, v71
  v_cvt_pk_bf16_f32 v166, v72, v73
  v_cvt_pk_bf16_f32 v167, v74, v75
  v_cvt_pk_bf16_f32 v214, v76, v77
  v_cvt_pk_bf16_f32 v215, v78, v79
  v_pk_fma_f32 v[68:69], v[44:45], v[44:45], s[50:51]
  v_add_f32_dpp v84, v80, v80 row_ror:8 row_mask:0xf bank_mask:0x3
  v_add_f32_dpp v84, v81, v81 row_ror:8 row_mask:0xf bank_mask:0xc
  v_pk_fma_f32 v[70:71], v[46:47], v[46:47], s[50:51]
  v_add_f32_dpp v85, v82, v82 row_ror:8 row_mask:0xf bank_mask:0x3
  v_add_f32_dpp v85, v83, v83 row_ror:8 row_mask:0xf bank_mask:0xc
  v_pk_fma_f32 v[72:73], v[48:49], v[48:49], s[50:51]
  v_pk_fma_f32 v[74:75], v[50:51], v[50:51], s[50:51]
  v_add_f32_dpp v86, v84, v84 row_half_mirror row_mask:0xf bank_mask:0x5
  v_add_f32_dpp v86, v85, v85 row_half_mirror row_mask:0xf bank_mask:0xa
  v_pk_fma_f32 v[76:77], v[52:53], v[52:53], s[50:51]
  v_pk_fma_f32 v[78:79], v[54:55], v[54:55], s[50:51]
  v_pk_mul_f32 v[68:69], v[68:69], v[44:45]
  v_add_f32_dpp v86, v86, v86 quad_perm:[1,0,3,2] row_mask:0xf bank_mask:0xf
  v_pk_mul_f32 v[70:71], v[70:71], v[46:47]
  v_pk_mul_f32 v[72:73], v[72:73], v[48:49]
  v_pk_mul_f32 v[74:75], v[74:75], v[50:51]
  v_add_f32_dpp v86, v86, v86 quad_perm:[2,3,0,1] row_mask:0xf bank_mask:0xf
  v_pk_mul_f32 v[76:77], v[76:77], v[52:53]
  v_pk_mul_f32 v[78:79], v[78:79], v[54:55]
  v_cndmask_b32 v89, v89, v86, s[54:55]
  s_waitcnt lgkmcnt(0)
  v_mfma_f32_16x16x32_bf16 v[56:59], a[72:75], v[8:11], 0
  v_exp_f32 v68, v68
  v_mfma_f32_16x16x32_bf16 v[60:63], a[72:75], v[20:23], 0
  s_add_u32 m0, s77, 9216
  s_add_u32 s67, s76, 9216
  buffer_load_dwordx4 v93, s[36:39], s67 offen offset:0 lds
  v_exp_f32_e64 v69, v69
  v_mfma_f32_16x16x32_bf16 v[64:67], a[72:75], v[32:35], 0
  v_exp_f32_e64 v70, v70
  v_mfma_f32_16x16x32_bf16 v[56:59], a[76:79], v[12:15], v[56:59]
  v_exp_f32_e64 v71, v71
  v_mfma_f32_16x16x32_bf16 v[60:63], a[76:79], v[24:27], v[60:63]
  v_exp_f32_e64 v72, v72
  v_mfma_f32_16x16x32_bf16 v[64:67], a[76:79], v[36:39], v[64:67]
  v_exp_f32_e64 v73, v73
  v_mfma_f32_16x16x32_bf16 v[56:59], a[80:83], v[16:19], v[56:59]
  v_exp_f32_e64 v74, v74
  v_mfma_f32_16x16x32_bf16 v[60:63], a[80:83], v[28:31], v[60:63]
  v_exp_f32_e64 v75, v75
  v_mfma_f32_16x16x32_bf16 v[64:67], a[80:83], v[40:43], v[64:67]
  s_add_u32 s66, s44, 2
  s_and_b32 s66, s66, 3
  s_mul_i32 s66, s66, 192
  v_add_u32_e64 v4, s66, v6
  ds_read_b64_tr_b16 a[72:73], v4 offset:0
  ds_read_b64_tr_b16 a[74:75], v4 offset:12800
  ds_read_b64_tr_b16 a[76:77], v4 offset:25600
  ds_read_b64_tr_b16 a[78:79], v4 offset:38400
  ds_read_b64_tr_b16 a[80:81], v4 offset:51200
  ds_read_b64_tr_b16 a[82:83], v4 offset:64000
  v_exp_f32 v76, v76
  v_exp_f32 v77, v77
  v_exp_f32 v78, v78
  v_exp_f32 v79, v79
  v_pk_add_f32 v[68:69], v[68:69], 1.0 op_sel_hi:[1,0]
  v_pk_add_f32 v[70:71], v[70:71], 1.0 op_sel_hi:[1,0]
  v_pk_add_f32 v[72:73], v[72:73], 1.0 op_sel_hi:[1,0]
  v_pk_add_f32 v[74:75], v[74:75], 1.0 op_sel_hi:[1,0]
  v_pk_add_f32 v[76:77], v[76:77], 1.0 op_sel_hi:[1,0]
  v_pk_add_f32 v[78:79], v[78:79], 1.0 op_sel_hi:[1,0]
  v_rcp_f32 v68, v68
  v_rcp_f32 v69, v69
  v_rcp_f32 v70, v70
  v_rcp_f32 v71, v71
  v_rcp_f32 v72, v72
  v_rcp_f32 v73, v73
  v_rcp_f32 v74, v74
  v_rcp_f32 v75, v75
  v_rcp_f32 v76, v76
  v_rcp_f32 v77, v77
  v_rcp_f32 v78, v78
  v_rcp_f32 v79, v79
  v_pk_mul_f32 v[68:69], v[68:69], v[44:45]
  v_pk_mul_f32 v[70:71], v[70:71], v[46:47]
  v_pk_mul_f32 v[72:73], v[72:73], v[48:49]
  v_pk_mul_f32 v[74:75], v[74:75], v[50:51]
  v_pk_mul_f32 v[76:77], v[76:77], v[52:53]
  v_pk_mul_f32 v[78:79], v[78:79], v[54:55]
  v_pk_mul_f32 v[80:81], v[68:69], v[68:69]
  v_pk_mul_f32 v[82:83], v[70:71], v[70:71]
  v_pk_fma_f32 v[80:81], v[72:73], v[72:73], v[80:81]
  v_pk_fma_f32 v[82:83], v[74:75], v[74:75], v[82:83]
  v_pk_fma_f32 v[80:81], v[76:77], v[76:77], v[80:81]
  v_pk_fma_f32 v[82:83], v[78:79], v[78:79], v[82:83]
  v_cvt_pk_bf16_f32 v120, v68, v69
  v_cvt_pk_bf16_f32 v121, v70, v71
  v_cvt_pk_bf16_f32 v168, v72, v73
  v_cvt_pk_bf16_f32 v169, v74, v75
  v_cvt_pk_bf16_f32 v216, v76, v77
  v_cvt_pk_bf16_f32 v217, v78, v79
  v_pk_fma_f32 v[68:69], v[56:57], v[56:57], s[50:51]
  v_add_f32_dpp v84, v80, v80 row_ror:8 row_mask:0xf bank_mask:0x3
  v_add_f32_dpp v84, v81, v81 row_ror:8 row_mask:0xf bank_mask:0xc
  v_pk_fma_f32 v[70:71], v[58:59], v[58:59], s[50:51]
  v_add_f32_dpp v85, v82, v82 row_ror:8 row_mask:0xf bank_mask:0x3
  v_add_f32_dpp v85, v83, v83 row_ror:8 row_mask:0xf bank_mask:0xc
  v_pk_fma_f32 v[72:73], v[60:61], v[60:61], s[50:51]
  v_pk_fma_f32 v[74:75], v[62:63], v[62:63], s[50:51]
  v_add_f32_dpp v86, v84, v84 row_half_mirror row_mask:0xf bank_mask:0x5
  v_add_f32_dpp v86, v85, v85 row_half_mirror row_mask:0xf bank_mask:0xa
  v_pk_fma_f32 v[76:77], v[64:65], v[64:65], s[50:51]
  v_pk_fma_f32 v[78:79], v[66:67], v[66:67], s[50:51]
  v_pk_mul_f32 v[68:69], v[68:69], v[56:57]
  v_add_f32_dpp v86, v86, v86 quad_perm:[1,0,3,2] row_mask:0xf bank_mask:0xf
  v_pk_mul_f32 v[70:71], v[70:71], v[58:59]
  v_pk_mul_f32 v[72:73], v[72:73], v[60:61]
  v_pk_mul_f32 v[74:75], v[74:75], v[62:63]
  v_add_f32_dpp v86, v86, v86 quad_perm:[2,3,0,1] row_mask:0xf bank_mask:0xf
  v_pk_mul_f32 v[76:77], v[76:77], v[64:65]
  v_pk_mul_f32 v[78:79], v[78:79], v[66:67]
  v_cndmask_b32 v89, v89, v86, s[56:57]
  s_waitcnt lgkmcnt(0)
  v_mfma_f32_16x16x32_bf16 v[44:47], a[72:75], v[8:11], 0
  v_exp_f32 v68, v68
  v_mfma_f32_16x16x32_bf16 v[48:51], a[72:75], v[20:23], 0
  buffer_load_dwordx4 v94, s[36:39], s67 offen offset:1024 lds
  v_exp_f32_e64 v69, v69
  v_mfma_f32_16x16x32_bf16 v[52:55], a[72:75], v[32:35], 0
  v_exp_f32_e64 v70, v70
  v_mfma_f32_16x16x32_bf16 v[44:47], a[76:79], v[12:15], v[44:47]
  v_exp_f32_e64 v71, v71
  v_mfma_f32_16x16x32_bf16 v[48:51], a[76:79], v[24:27], v[48:51]
  v_exp_f32_e64 v72, v72
  v_mfma_f32_16x16x32_bf16 v[52:55], a[76:79], v[36:39], v[52:55]
  v_exp_f32_e64 v73, v73
  v_mfma_f32_16x16x32_bf16 v[44:47], a[80:83], v[16:19], v[44:47]
  v_exp_f32_e64 v74, v74
  v_mfma_f32_16x16x32_bf16 v[48:51], a[80:83], v[28:31], v[48:51]
  v_exp_f32_e64 v75, v75
  v_mfma_f32_16x16x32_bf16 v[52:55], a[80:83], v[40:43], v[52:55]
  ds_read_b64_tr_b16 a[72:73], v4 offset:32
  ds_read_b64_tr_b16 a[74:75], v4 offset:12832
  ds_read_b64_tr_b16 a[76:77], v4 offset:25632
  ds_read_b64_tr_b16 a[78:79], v4 offset:38432
  ds_read_b64_tr_b16 a[80:81], v4 offset:51232
  ds_read_b64_tr_b16 a[82:83], v4 offset:64032
  v_exp_f32 v76, v76
  v_exp_f32 v77, v77
  v_exp_f32 v78, v78
  v_exp_f32 v79, v79
  v_pk_add_f32 v[68:69], v[68:69], 1.0 op_sel_hi:[1,0]
  v_pk_add_f32 v[70:71], v[70:71], 1.0 op_sel_hi:[1,0]
  v_pk_add_f32 v[72:73], v[72:73], 1.0 op_sel_hi:[1,0]
  v_pk_add_f32 v[74:75], v[74:75], 1.0 op_sel_hi:[1,0]
  v_pk_add_f32 v[76:77], v[76:77], 1.0 op_sel_hi:[1,0]
  v_pk_add_f32 v[78:79], v[78:79], 1.0 op_sel_hi:[1,0]
  v_rcp_f32 v68, v68
  v_rcp_f32 v69, v69
  v_rcp_f32 v70, v70
  v_rcp_f32 v71, v71
  v_rcp_f32 v72, v72
  v_rcp_f32 v73, v73
  v_rcp_f32 v74, v74
  v_rcp_f32 v75, v75
  v_rcp_f32 v76, v76
  v_rcp_f32 v77, v77
  v_rcp_f32 v78, v78
  v_rcp_f32 v79, v79
  v_pk_mul_f32 v[68:69], v[68:69], v[56:57]
  v_pk_mul_f32 v[70:71], v[70:71], v[58:59]
  v_pk_mul_f32 v[72:73], v[72:73], v[60:61]
  v_pk_mul_f32 v[74:75], v[74:75], v[62:63]
  v_pk_mul_f32 v[76:77], v[76:77], v[64:65]
  v_pk_mul_f32 v[78:79], v[78:79], v[66:67]
  v_pk_mul_f32 v[80:81], v[68:69], v[68:69]
  v_pk_mul_f32 v[82:83], v[70:71], v[70:71]
  v_pk_fma_f32 v[80:81], v[72:73], v[72:73], v[80:81]
  v_pk_fma_f32 v[82:83], v[74:75], v[74:75], v[82:83]
  v_pk_fma_f32 v[80:81], v[76:77], v[76:77], v[80:81]
  v_pk_fma_f32 v[82:83], v[78:79], v[78:79], v[82:83]
  v_cvt_pk_bf16_f32 v122, v68, v69
  v_cvt_pk_bf16_f32 v123, v70, v71
  v_cvt_pk_bf16_f32 v170, v72, v73
  v_cvt_pk_bf16_f32 v171, v74, v75
  v_cvt_pk_bf16_f32 v218, v76, v77
  v_cvt_pk_bf16_f32 v219, v78, v79
  v_pk_fma_f32 v[68:69], v[44:45], v[44:45], s[50:51]
  v_add_f32_dpp v84, v80, v80 row_ror:8 row_mask:0xf bank_mask:0x3
  v_add_f32_dpp v84, v81, v81 row_ror:8 row_mask:0xf bank_mask:0xc
  v_pk_fma_f32 v[70:71], v[46:47], v[46:47], s[50:51]
  v_add_f32_dpp v85, v82, v82 row_ror:8 row_mask:0xf bank_mask:0x3
  v_add_f32_dpp v85, v83, v83 row_ror:8 row_mask:0xf bank_mask:0xc
  v_pk_fma_f32 v[72:73], v[48:49], v[48:49], s[50:51]
  v_pk_fma_f32 v[74:75], v[50:51], v[50:51], s[50:51]
  v_add_f32_dpp v86, v84, v84 row_half_mirror row_mask:0xf bank_mask:0x5
  v_add_f32_dpp v86, v85, v85 row_half_mirror row_mask:0xf bank_mask:0xa
  v_pk_fma_f32 v[76:77], v[52:53], v[52:53], s[50:51]
  v_pk_fma_f32 v[78:79], v[54:55], v[54:55], s[50:51]
  v_pk_mul_f32 v[68:69], v[68:69], v[44:45]
  v_add_f32_dpp v86, v86, v86 quad_perm:[1,0,3,2] row_mask:0xf bank_mask:0xf
  v_pk_mul_f32 v[70:71], v[70:71], v[46:47]
  v_pk_mul_f32 v[72:73], v[72:73], v[48:49]
  v_pk_mul_f32 v[74:75], v[74:75], v[50:51]
  v_add_f32_dpp v86, v86, v86 quad_perm:[2,3,0,1] row_mask:0xf bank_mask:0xf
  v_pk_mul_f32 v[76:77], v[76:77], v[52:53]
  v_pk_mul_f32 v[78:79], v[78:79], v[54:55]
  v_cndmask_b32 v89, v89, v86, s[58:59]
  s_waitcnt lgkmcnt(0)
  v_mfma_f32_16x16x32_bf16 v[56:59], a[72:75], v[8:11], 0
  v_exp_f32 v68, v68
  v_mfma_f32_16x16x32_bf16 v[60:63], a[72:75], v[20:23], 0
  buffer_load_dwordx4 v95, s[36:39], s67 offen offset:2048 lds
  v_exp_f32_e64 v69, v69
  v_mfma_f32_16x16x32_bf16 v[64:67], a[72:75], v[32:35], 0
  v_exp_f32_e64 v70, v70
  v_mfma_f32_16x16x32_bf16 v[56:59], a[76:79], v[12:15], v[56:59]
  v_exp_f32_e64 v71, v71
  v_mfma_f32_16x16x32_bf16 v[60:63], a[76:79], v[24:27], v[60:63]
  v_exp_f32_e64 v72, v72
  v_mfma_f32_16x16x32_bf16 v[64:67], a[76:79], v[36:39], v[64:67]
  v_exp_f32_e64 v73, v73
  v_mfma_f32_16x16x32_bf16 v[56:59], a[80:83], v[16:19], v[56:59]
  v_exp_f32_e64 v74, v74
  v_mfma_f32_16x16x32_bf16 v[60:63], a[80:83], v[28:31], v[60:63]
  v_exp_f32_e64 v75, v75
  v_mfma_f32_16x16x32_bf16 v[64:67], a[80:83], v[40:43], v[64:67]
  ds_read_b64_tr_b16 a[72:73], v4 offset:64
  ds_read_b64_tr_b16 a[74:75], v4 offset:12864
  ds_read_b64_tr_b16 a[76:77], v4 offset:25664
  ds_read_b64_tr_b16 a[78:79], v4 offset:38464
  ds_read_b64_tr_b16 a[80:81], v4 offset:51264
  ds_read_b64_tr_b16 a[82:83], v4 offset:64064
  v_exp_f32 v76, v76
  v_exp_f32 v77, v77
  v_exp_f32 v78, v78
  v_exp_f32 v79, v79
  v_pk_add_f32 v[68:69], v[68:69], 1.0 op_sel_hi:[1,0]
  v_pk_add_f32 v[70:71], v[70:71], 1.0 op_sel_hi:[1,0]
  v_pk_add_f32 v[72:73], v[72:73], 1.0 op_sel_hi:[1,0]
  v_pk_add_f32 v[74:75], v[74:75], 1.0 op_sel_hi:[1,0]
  v_pk_add_f32 v[76:77], v[76:77], 1.0 op_sel_hi:[1,0]
  v_pk_add_f32 v[78:79], v[78:79], 1.0 op_sel_hi:[1,0]
  v_rcp_f32 v68, v68
  v_rcp_f32 v69, v69
  v_rcp_f32 v70, v70
  v_rcp_f32 v71, v71
  v_rcp_f32 v72, v72
  v_rcp_f32 v73, v73
  v_rcp_f32 v74, v74
  v_rcp_f32 v75, v75
  v_rcp_f32 v76, v76
  v_rcp_f32 v77, v77
  v_rcp_f32 v78, v78
  v_rcp_f32 v79, v79
  v_pk_mul_f32 v[68:69], v[68:69], v[44:45]
  v_pk_mul_f32 v[70:71], v[70:71], v[46:47]
  v_pk_mul_f32 v[72:73], v[72:73], v[48:49]
  v_pk_mul_f32 v[74:75], v[74:75], v[50:51]
  v_pk_mul_f32 v[76:77], v[76:77], v[52:53]
  v_pk_mul_f32 v[78:79], v[78:79], v[54:55]
  v_pk_mul_f32 v[80:81], v[68:69], v[68:69]
  v_pk_mul_f32 v[82:83], v[70:71], v[70:71]
  v_pk_fma_f32 v[80:81], v[72:73], v[72:73], v[80:81]
  v_pk_fma_f32 v[82:83], v[74:75], v[74:75], v[82:83]
  v_pk_fma_f32 v[80:81], v[76:77], v[76:77], v[80:81]
  v_pk_fma_f32 v[82:83], v[78:79], v[78:79], v[82:83]
  v_cvt_pk_bf16_f32 v124, v68, v69
  v_cvt_pk_bf16_f32 v125, v70, v71
  v_cvt_pk_bf16_f32 v172, v72, v73
  v_cvt_pk_bf16_f32 v173, v74, v75
  v_cvt_pk_bf16_f32 v220, v76, v77
  v_cvt_pk_bf16_f32 v221, v78, v79
  v_pk_fma_f32 v[68:69], v[56:57], v[56:57], s[50:51]
  v_add_f32_dpp v84, v80, v80 row_ror:8 row_mask:0xf bank_mask:0x3
  v_add_f32_dpp v84, v81, v81 row_ror:8 row_mask:0xf bank_mask:0xc
  v_pk_fma_f32 v[70:71], v[58:59], v[58:59], s[50:51]
  v_add_f32_dpp v85, v82, v82 row_ror:8 row_mask:0xf bank_mask:0x3
  v_add_f32_dpp v85, v83, v83 row_ror:8 row_mask:0xf bank_mask:0xc
  v_pk_fma_f32 v[72:73], v[60:61], v[60:61], s[50:51]
  v_pk_fma_f32 v[74:75], v[62:63], v[62:63], s[50:51]
  v_add_f32_dpp v86, v84, v84 row_half_mirror row_mask:0xf bank_mask:0x5
  v_add_f32_dpp v86, v85, v85 row_half_mirror row_mask:0xf bank_mask:0xa
  v_pk_fma_f32 v[76:77], v[64:65], v[64:65], s[50:51]
  v_pk_fma_f32 v[78:79], v[66:67], v[66:67], s[50:51]
  v_pk_mul_f32 v[68:69], v[68:69], v[56:57]
  v_add_f32_dpp v86, v86, v86 quad_perm:[1,0,3,2] row_mask:0xf bank_mask:0xf
  v_pk_mul_f32 v[70:71], v[70:71], v[58:59]
  v_pk_mul_f32 v[72:73], v[72:73], v[60:61]
  v_pk_mul_f32 v[74:75], v[74:75], v[62:63]
  v_add_f32_dpp v86, v86, v86 quad_perm:[2,3,0,1] row_mask:0xf bank_mask:0xf
  v_pk_mul_f32 v[76:77], v[76:77], v[64:65]
  v_pk_mul_f32 v[78:79], v[78:79], v[66:67]
  v_cndmask_b32 v90, v90, v86, s[52:53]
  s_waitcnt lgkmcnt(0)
  v_mfma_f32_16x16x32_bf16 v[44:47], a[72:75], v[8:11], 0
  v_exp_f32 v68, v68
  v_mfma_f32_16x16x32_bf16 v[48:51], a[72:75], v[20:23], 0
  s_add_u32 m0, s77, 12288
  s_add_u32 s67, s76, 12288
  buffer_load_dwordx4 v93, s[36:39], s67 offen offset:0 lds
  v_exp_f32_e64 v69, v69
  v_mfma_f32_16x16x32_bf16 v[52:55], a[72:75], v[32:35], 0
  v_exp_f32_e64 v70, v70
  v_mfma_f32_16x16x32_bf16 v[44:47], a[76:79], v[12:15], v[44:47]
  v_exp_f32_e64 v71, v71
  v_mfma_f32_16x16x32_bf16 v[48:51], a[76:79], v[24:27], v[48:51]
  v_exp_f32_e64 v72, v72
  v_mfma_f32_16x16x32_bf16 v[52:55], a[76:79], v[36:39], v[52:55]
  v_exp_f32_e64 v73, v73
  v_mfma_f32_16x16x32_bf16 v[44:47], a[80:83], v[16:19], v[44:47]
  v_exp_f32_e64 v74, v74
  v_mfma_f32_16x16x32_bf16 v[48:51], a[80:83], v[28:31], v[48:51]
  v_exp_f32_e64 v75, v75
  v_mfma_f32_16x16x32_bf16 v[52:55], a[80:83], v[40:43], v[52:55]
  ds_read_b64_tr_b16 a[72:73], v4 offset:96
  ds_read_b64_tr_b16 a[74:75], v4 offset:12896
  ds_read_b64_tr_b16 a[76:77], v4 offset:25696
  ds_read_b64_tr_b16 a[78:79], v4 offset:38496
  ds_read_b64_tr_b16 a[80:81], v4 offset:51296
  ds_read_b64_tr_b16 a[82:83], v4 offset:64096
  v_exp_f32 v76, v76
  v_exp_f32 v77, v77
  v_exp_f32 v78, v78
  v_exp_f32 v79, v79
  v_pk_add_f32 v[68:69], v[68:69], 1.0 op_sel_hi:[1,0]
  v_pk_add_f32 v[70:71], v[70:71], 1.0 op_sel_hi:[1,0]
  v_pk_add_f32 v[72:73], v[72:73], 1.0 op_sel_hi:[1,0]
  v_pk_add_f32 v[74:75], v[74:75], 1.0 op_sel_hi:[1,0]
  v_pk_add_f32 v[76:77], v[76:77], 1.0 op_sel_hi:[1,0]
  v_pk_add_f32 v[78:79], v[78:79], 1.0 op_sel_hi:[1,0]
  v_rcp_f32 v68, v68
  v_rcp_f32 v69, v69
  v_rcp_f32 v70, v70
  v_rcp_f32 v71, v71
  v_rcp_f32 v72, v72
  v_rcp_f32 v73, v73
  v_rcp_f32 v74, v74
  v_rcp_f32 v75, v75
  v_rcp_f32 v76, v76
  v_rcp_f32 v77, v77
  v_rcp_f32 v78, v78
  v_rcp_f32 v79, v79
  v_pk_mul_f32 v[68:69], v[68:69], v[56:57]
  v_pk_mul_f32 v[70:71], v[70:71], v[58:59]
  v_pk_mul_f32 v[72:73], v[72:73], v[60:61]
  v_pk_mul_f32 v[74:75], v[74:75], v[62:63]
  v_pk_mul_f32 v[76:77], v[76:77], v[64:65]
  v_pk_mul_f32 v[78:79], v[78:79], v[66:67]
  v_pk_mul_f32 v[80:81], v[68:69], v[68:69]
  v_pk_mul_f32 v[82:83], v[70:71], v[70:71]
  v_pk_fma_f32 v[80:81], v[72:73], v[72:73], v[80:81]
  v_pk_fma_f32 v[82:83], v[74:75], v[74:75], v[82:83]
  v_pk_fma_f32 v[80:81], v[76:77], v[76:77], v[80:81]
  v_pk_fma_f32 v[82:83], v[78:79], v[78:79], v[82:83]
  v_cvt_pk_bf16_f32 v126, v68, v69
  v_cvt_pk_bf16_f32 v127, v70, v71
  v_cvt_pk_bf16_f32 v174, v72, v73
  v_cvt_pk_bf16_f32 v175, v74, v75
  v_cvt_pk_bf16_f32 v222, v76, v77
  v_cvt_pk_bf16_f32 v223, v78, v79
  v_pk_fma_f32 v[68:69], v[44:45], v[44:45], s[50:51]
  v_add_f32_dpp v84, v80, v80 row_ror:8 row_mask:0xf bank_mask:0x3
  v_add_f32_dpp v84, v81, v81 row_ror:8 row_mask:0xf bank_mask:0xc
  v_pk_fma_f32 v[70:71], v[46:47], v[46:47], s[50:51]
  v_add_f32_dpp v85, v82, v82 row_ror:8 row_mask:0xf bank_mask:0x3
  v_add_f32_dpp v85, v83, v83 row_ror:8 row_mask:0xf bank_mask:0xc
  v_pk_fma_f32 v[72:73], v[48:49], v[48:49], s[50:51]
  v_pk_fma_f32 v[74:75], v[50:51], v[50:51], s[50:51]
  v_add_f32_dpp v86, v84, v84 row_half_mirror row_mask:0xf bank_mask:0x5
  v_add_f32_dpp v86, v85, v85 row_half_mirror row_mask:0xf bank_mask:0xa
  v_pk_fma_f32 v[76:77], v[52:53], v[52:53], s[50:51]
  v_pk_fma_f32 v[78:79], v[54:55], v[54:55], s[50:51]
  v_pk_mul_f32 v[68:69], v[68:69], v[44:45]
  v_add_f32_dpp v86, v86, v86 quad_perm:[1,0,3,2] row_mask:0xf bank_mask:0xf
  v_pk_mul_f32 v[70:71], v[70:71], v[46:47]
  v_pk_mul_f32 v[72:73], v[72:73], v[48:49]
  v_pk_mul_f32 v[74:75], v[74:75], v[50:51]
  v_add_f32_dpp v86, v86, v86 quad_perm:[2,3,0,1] row_mask:0xf bank_mask:0xf
  v_pk_mul_f32 v[76:77], v[76:77], v[52:53]
  v_pk_mul_f32 v[78:79], v[78:79], v[54:55]
  v_cndmask_b32 v90, v90, v86, s[54:55]
  s_waitcnt lgkmcnt(0)
  v_mfma_f32_16x16x32_bf16 v[56:59], a[72:75], v[8:11], 0
  v_exp_f32 v68, v68
  v_mfma_f32_16x16x32_bf16 v[60:63], a[72:75], v[20:23], 0
  buffer_load_dwordx4 v94, s[36:39], s67 offen offset:1024 lds
  v_exp_f32_e64 v69, v69
  v_mfma_f32_16x16x32_bf16 v[64:67], a[72:75], v[32:35], 0
  v_exp_f32_e64 v70, v70
  v_mfma_f32_16x16x32_bf16 v[56:59], a[76:79], v[12:15], v[56:59]
  v_exp_f32_e64 v71, v71
  v_mfma_f32_16x16x32_bf16 v[60:63], a[76:79], v[24:27], v[60:63]
  v_exp_f32_e64 v72, v72
  v_mfma_f32_16x16x32_bf16 v[64:67], a[76:79], v[36:39], v[64:67]
  v_exp_f32_e64 v73, v73
  v_mfma_f32_16x16x32_bf16 v[56:59], a[80:83], v[16:19], v[56:59]
  v_exp_f32_e64 v74, v74
  v_mfma_f32_16x16x32_bf16 v[60:63], a[80:83], v[28:31], v[60:63]
  v_exp_f32_e64 v75, v75
  v_mfma_f32_16x16x32_bf16 v[64:67], a[80:83], v[40:43], v[64:67]
  ds_read_b64_tr_b16 a[72:73], v4 offset:128
  ds_read_b64_tr_b16 a[74:75], v4 offset:12928
  ds_read_b64_tr_b16 a[76:77], v4 offset:25728
  ds_read_b64_tr_b16 a[78:79], v4 offset:38528
  ds_read_b64_tr_b16 a[80:81], v4 offset:51328
  ds_read_b64_tr_b16 a[82:83], v4 offset:64128
  v_exp_f32 v76, v76
  v_exp_f32 v77, v77
  v_exp_f32 v78, v78
  v_exp_f32 v79, v79
  v_pk_add_f32 v[68:69], v[68:69], 1.0 op_sel_hi:[1,0]
  v_pk_add_f32 v[70:71], v[70:71], 1.0 op_sel_hi:[1,0]
  v_pk_add_f32 v[72:73], v[72:73], 1.0 op_sel_hi:[1,0]
  v_pk_add_f32 v[74:75], v[74:75], 1.0 op_sel_hi:[1,0]
  v_pk_add_f32 v[76:77], v[76:77], 1.0 op_sel_hi:[1,0]
  v_pk_add_f32 v[78:79], v[78:79], 1.0 op_sel_hi:[1,0]
  v_rcp_f32 v68, v68
  v_rcp_f32 v69, v69
  v_rcp_f32 v70, v70
  v_rcp_f32 v71, v71
  v_rcp_f32 v72, v72
  v_rcp_f32 v73, v73
  v_rcp_f32 v74, v74
  v_rcp_f32 v75, v75
  v_rcp_f32 v76, v76
  v_rcp_f32 v77, v77
  v_rcp_f32 v78, v78
  v_rcp_f32 v79, v79
  v_pk_mul_f32 v[68:69], v[68:69], v[44:45]
  v_pk_mul_f32 v[70:71], v[70:71], v[46:47]
  v_pk_mul_f32 v[72:73], v[72:73], v[48:49]
  v_pk_mul_f32 v[74:75], v[74:75], v[50:51]
  v_pk_mul_f32 v[76:77], v[76:77], v[52:53]
  v_pk_mul_f32 v[78:79], v[78:79], v[54:55]
  v_pk_mul_f32 v[80:81], v[68:69], v[68:69]
  v_pk_mul_f32 v[82:83], v[70:71], v[70:71]
  v_pk_fma_f32 v[80:81], v[72:73], v[72:73], v[80:81]
  v_pk_fma_f32 v[82:83], v[74:75], v[74:75], v[82:83]
  v_pk_fma_f32 v[80:81], v[76:77], v[76:77], v[80:81]
  v_pk_fma_f32 v[82:83], v[78:79], v[78:79], v[82:83]
  v_cvt_pk_bf16_f32 v128, v68, v69
  v_cvt_pk_bf16_f32 v129, v70, v71
  v_cvt_pk_bf16_f32 v176, v72, v73
  v_cvt_pk_bf16_f32 v177, v74, v75
  v_cvt_pk_bf16_f32 v224, v76, v77
  v_cvt_pk_bf16_f32 v225, v78, v79
  v_pk_fma_f32 v[68:69], v[56:57], v[56:57], s[50:51]
  v_add_f32_dpp v84, v80, v80 row_ror:8 row_mask:0xf bank_mask:0x3
  v_add_f32_dpp v84, v81, v81 row_ror:8 row_mask:0xf bank_mask:0xc
  v_pk_fma_f32 v[70:71], v[58:59], v[58:59], s[50:51]
  v_add_f32_dpp v85, v82, v82 row_ror:8 row_mask:0xf bank_mask:0x3
  v_add_f32_dpp v85, v83, v83 row_ror:8 row_mask:0xf bank_mask:0xc
  v_pk_fma_f32 v[72:73], v[60:61], v[60:61], s[50:51]
  v_pk_fma_f32 v[74:75], v[62:63], v[62:63], s[50:51]
  v_add_f32_dpp v86, v84, v84 row_half_mirror row_mask:0xf bank_mask:0x5
  v_add_f32_dpp v86, v85, v85 row_half_mirror row_mask:0xf bank_mask:0xa
  v_pk_fma_f32 v[76:77], v[64:65], v[64:65], s[50:51]
  v_pk_fma_f32 v[78:79], v[66:67], v[66:67], s[50:51]
  v_pk_mul_f32 v[68:69], v[68:69], v[56:57]
  v_add_f32_dpp v86, v86, v86 quad_perm:[1,0,3,2] row_mask:0xf bank_mask:0xf
  v_pk_mul_f32 v[70:71], v[70:71], v[58:59]
  v_pk_mul_f32 v[72:73], v[72:73], v[60:61]
  v_pk_mul_f32 v[74:75], v[74:75], v[62:63]
  v_add_f32_dpp v86, v86, v86 quad_perm:[2,3,0,1] row_mask:0xf bank_mask:0xf
  v_pk_mul_f32 v[76:77], v[76:77], v[64:65]
  v_pk_mul_f32 v[78:79], v[78:79], v[66:67]
  v_cndmask_b32 v90, v90, v86, s[56:57]
  s_waitcnt lgkmcnt(0)
  v_mfma_f32_16x16x32_bf16 v[44:47], a[72:75], v[8:11], 0
  v_exp_f32 v68, v68
  v_mfma_f32_16x16x32_bf16 v[48:51], a[72:75], v[20:23], 0
  buffer_load_dwordx4 v95, s[36:39], s67 offen offset:2048 lds
  v_exp_f32_e64 v69, v69
  v_mfma_f32_16x16x32_bf16 v[52:55], a[72:75], v[32:35], 0
  v_exp_f32_e64 v70, v70
  v_mfma_f32_16x16x32_bf16 v[44:47], a[76:79], v[12:15], v[44:47]
  v_exp_f32_e64 v71, v71
  v_mfma_f32_16x16x32_bf16 v[48:51], a[76:79], v[24:27], v[48:51]
  v_exp_f32_e64 v72, v72
  v_mfma_f32_16x16x32_bf16 v[52:55], a[76:79], v[36:39], v[52:55]
  v_exp_f32_e64 v73, v73
  v_mfma_f32_16x16x32_bf16 v[44:47], a[80:83], v[16:19], v[44:47]
  v_exp_f32_e64 v74, v74
  v_mfma_f32_16x16x32_bf16 v[48:51], a[80:83], v[28:31], v[48:51]
  v_exp_f32_e64 v75, v75
  v_mfma_f32_16x16x32_bf16 v[52:55], a[80:83], v[40:43], v[52:55]
  ds_read_b64_tr_b16 a[72:73], v4 offset:160
  ds_read_b64_tr_b16 a[74:75], v4 offset:12960
  ds_read_b64_tr_b16 a[76:77], v4 offset:25760
  ds_read_b64_tr_b16 a[78:79], v4 offset:38560
  ds_read_b64_tr_b16 a[80:81], v4 offset:51360
  ds_read_b64_tr_b16 a[82:83], v4 offset:64160
  v_exp_f32 v76, v76
  v_exp_f32 v77, v77
  v_exp_f32 v78, v78
  v_exp_f32 v79, v79
  v_pk_add_f32 v[68:69], v[68:69], 1.0 op_sel_hi:[1,0]
  v_pk_add_f32 v[70:71], v[70:71], 1.0 op_sel_hi:[1,0]
  v_pk_add_f32 v[72:73], v[72:73], 1.0 op_sel_hi:[1,0]
  v_pk_add_f32 v[74:75], v[74:75], 1.0 op_sel_hi:[1,0]
  v_pk_add_f32 v[76:77], v[76:77], 1.0 op_sel_hi:[1,0]
  v_pk_add_f32 v[78:79], v[78:79], 1.0 op_sel_hi:[1,0]
  v_rcp_f32 v68, v68
  v_rcp_f32 v69, v69
  v_rcp_f32 v70, v70
  v_rcp_f32 v71, v71
  v_rcp_f32 v72, v72
  v_rcp_f32 v73, v73
  v_rcp_f32 v74, v74
  v_rcp_f32 v75, v75
  v_rcp_f32 v76, v76
  v_rcp_f32 v77, v77
  v_rcp_f32 v78, v78
  v_rcp_f32 v79, v79
  v_pk_mul_f32 v[68:69], v[68:69], v[56:57]
  v_pk_mul_f32 v[70:71], v[70:71], v[58:59]
  v_pk_mul_f32 v[72:73], v[72:73], v[60:61]
  v_pk_mul_f32 v[74:75], v[74:75], v[62:63]
  v_pk_mul_f32 v[76:77], v[76:77], v[64:65]
  v_pk_mul_f32 v[78:79], v[78:79], v[66:67]
  v_pk_mul_f32 v[80:81], v[68:69], v[68:69]
  v_pk_mul_f32 v[82:83], v[70:71], v[70:71]
  v_pk_fma_f32 v[80:81], v[72:73], v[72:73], v[80:81]
  v_pk_fma_f32 v[82:83], v[74:75], v[74:75], v[82:83]
  v_pk_fma_f32 v[80:81], v[76:77], v[76:77], v[80:81]
  v_pk_fma_f32 v[82:83], v[78:79], v[78:79], v[82:83]
  v_cvt_pk_bf16_f32 v130, v68, v69
  v_cvt_pk_bf16_f32 v131, v70, v71
  v_cvt_pk_bf16_f32 v178, v72, v73
  v_cvt_pk_bf16_f32 v179, v74, v75
  v_cvt_pk_bf16_f32 v226, v76, v77
  v_cvt_pk_bf16_f32 v227, v78, v79
  v_pk_fma_f32 v[68:69], v[44:45], v[44:45], s[50:51]
  v_add_f32_dpp v84, v80, v80 row_ror:8 row_mask:0xf bank_mask:0x3
  v_add_f32_dpp v84, v81, v81 row_ror:8 row_mask:0xf bank_mask:0xc
  v_pk_fma_f32 v[70:71], v[46:47], v[46:47], s[50:51]
  v_add_f32_dpp v85, v82, v82 row_ror:8 row_mask:0xf bank_mask:0x3
  v_add_f32_dpp v85, v83, v83 row_ror:8 row_mask:0xf bank_mask:0xc
  v_pk_fma_f32 v[72:73], v[48:49], v[48:49], s[50:51]
  v_pk_fma_f32 v[74:75], v[50:51], v[50:51], s[50:51]
  v_add_f32_dpp v86, v84, v84 row_half_mirror row_mask:0xf bank_mask:0x5
  v_add_f32_dpp v86, v85, v85 row_half_mirror row_mask:0xf bank_mask:0xa
  v_pk_fma_f32 v[76:77], v[52:53], v[52:53], s[50:51]
  v_pk_fma_f32 v[78:79], v[54:55], v[54:55], s[50:51]
  v_pk_mul_f32 v[68:69], v[68:69], v[44:45]
  v_add_f32_dpp v86, v86, v86 quad_perm:[1,0,3,2] row_mask:0xf bank_mask:0xf
  v_pk_mul_f32 v[70:71], v[70:71], v[46:47]
  v_pk_mul_f32 v[72:73], v[72:73], v[48:49]
  v_pk_mul_f32 v[74:75], v[74:75], v[50:51]
  v_add_f32_dpp v86, v86, v86 quad_perm:[2,3,0,1] row_mask:0xf bank_mask:0xf
  v_pk_mul_f32 v[76:77], v[76:77], v[52:53]
  v_pk_mul_f32 v[78:79], v[78:79], v[54:55]
  v_cndmask_b32 v90, v90, v86, s[58:59]
  s_waitcnt lgkmcnt(0)
  v_mfma_f32_16x16x32_bf16 v[56:59], a[72:75], v[8:11], 0
  v_exp_f32 v68, v68
  v_mfma_f32_16x16x32_bf16 v[60:63], a[72:75], v[20:23], 0
  s_add_u32 m0, s77, 15360
  s_add_u32 s67, s76, 15360
  buffer_load_dwordx4 v93, s[36:39], s67 offen offset:0 lds
  v_exp_f32_e64 v69, v69
  v_mfma_f32_16x16x32_bf16 v[64:67], a[72:75], v[32:35], 0
  v_exp_f32_e64 v70, v70
  v_mfma_f32_16x16x32_bf16 v[56:59], a[76:79], v[12:15], v[56:59]
  v_exp_f32_e64 v71, v71
  v_mfma_f32_16x16x32_bf16 v[60:63], a[76:79], v[24:27], v[60:63]
  v_exp_f32_e64 v72, v72
  v_mfma_f32_16x16x32_bf16 v[64:67], a[76:79], v[36:39], v[64:67]
  v_exp_f32_e64 v73, v73
  v_mfma_f32_16x16x32_bf16 v[56:59], a[80:83], v[16:19], v[56:59]
  v_exp_f32_e64 v74, v74
  v_mfma_f32_16x16x32_bf16 v[60:63], a[80:83], v[28:31], v[60:63]
  v_exp_f32_e64 v75, v75
  v_mfma_f32_16x16x32_bf16 v[64:67], a[80:83], v[40:43], v[64:67]
  s_add_u32 s66, s44, 3
  s_and_b32 s66, s66, 3
  s_mul_i32 s66, s66, 192
  v_add_u32_e64 v4, s66, v6
  ds_read_b64_tr_b16 a[72:73], v4 offset:0
  ds_read_b64_tr_b16 a[74:75], v4 offset:12800
  ds_read_b64_tr_b16 a[76:77], v4 offset:25600
  ds_read_b64_tr_b16 a[78:79], v4 offset:38400
  ds_read_b64_tr_b16 a[80:81], v4 offset:51200
  ds_read_b64_tr_b16 a[82:83], v4 offset:64000
  v_exp_f32 v76, v76
  v_exp_f32 v77, v77
  v_exp_f32 v78, v78
  v_exp_f32 v79, v79
  v_pk_add_f32 v[68:69], v[68:69], 1.0 op_sel_hi:[1,0]
  v_pk_add_f32 v[70:71], v[70:71], 1.0 op_sel_hi:[1,0]
  v_pk_add_f32 v[72:73], v[72:73], 1.0 op_sel_hi:[1,0]
  v_pk_add_f32 v[74:75], v[74:75], 1.0 op_sel_hi:[1,0]
  v_pk_add_f32 v[76:77], v[76:77], 1.0 op_sel_hi:[1,0]
  v_pk_add_f32 v[78:79], v[78:79], 1.0 op_sel_hi:[1,0]
  v_rcp_f32 v68, v68
  v_rcp_f32 v69, v69
  v_rcp_f32 v70, v70
  v_rcp_f32 v71, v71
  v_rcp_f32 v72, v72
  v_rcp_f32 v73, v73
  v_rcp_f32 v74, v74
  v_rcp_f32 v75, v75
  v_rcp_f32 v76, v76
  v_rcp_f32 v77, v77
  v_rcp_f32 v78, v78
  v_rcp_f32 v79, v79
  v_pk_mul_f32 v[68:69], v[68:69], v[44:45]
  v_pk_mul_f32 v[70:71], v[70:71], v[46:47]
  v_pk_mul_f32 v[72:73], v[72:73], v[48:49]
  v_pk_mul_f32 v[74:75], v[74:75], v[50:51]
  v_pk_mul_f32 v[76:77], v[76:77], v[52:53]
  v_pk_mul_f32 v[78:79], v[78:79], v[54:55]
  v_pk_mul_f32 v[80:81], v[68:69], v[68:69]
  v_pk_mul_f32 v[82:83], v[70:71], v[70:71]
  v_pk_fma_f32 v[80:81], v[72:73], v[72:73], v[80:81]
  v_pk_fma_f32 v[82:83], v[74:75], v[74:75], v[82:83]
  v_pk_fma_f32 v[80:81], v[76:77], v[76:77], v[80:81]
  v_pk_fma_f32 v[82:83], v[78:79], v[78:79], v[82:83]
  v_cvt_pk_bf16_f32 v132, v68, v69
  v_cvt_pk_bf16_f32 v133, v70, v71
  v_cvt_pk_bf16_f32 v180, v72, v73
  v_cvt_pk_bf16_f32 v181, v74, v75
  v_cvt_pk_bf16_f32 v228, v76, v77
  v_cvt_pk_bf16_f32 v229, v78, v79
  v_pk_fma_f32 v[68:69], v[56:57], v[56:57], s[50:51]
  v_add_f32_dpp v84, v80, v80 row_ror:8 row_mask:0xf bank_mask:0x3
  v_add_f32_dpp v84, v81, v81 row_ror:8 row_mask:0xf bank_mask:0xc
  v_pk_fma_f32 v[70:71], v[58:59], v[58:59], s[50:51]
  v_add_f32_dpp v85, v82, v82 row_ror:8 row_mask:0xf bank_mask:0x3
  v_add_f32_dpp v85, v83, v83 row_ror:8 row_mask:0xf bank_mask:0xc
  v_pk_fma_f32 v[72:73], v[60:61], v[60:61], s[50:51]
  v_pk_fma_f32 v[74:75], v[62:63], v[62:63], s[50:51]
  v_add_f32_dpp v86, v84, v84 row_half_mirror row_mask:0xf bank_mask:0x5
  v_add_f32_dpp v86, v85, v85 row_half_mirror row_mask:0xf bank_mask:0xa
  v_pk_fma_f32 v[76:77], v[64:65], v[64:65], s[50:51]
  v_pk_fma_f32 v[78:79], v[66:67], v[66:67], s[50:51]
  v_pk_mul_f32 v[68:69], v[68:69], v[56:57]
  v_add_f32_dpp v86, v86, v86 quad_perm:[1,0,3,2] row_mask:0xf bank_mask:0xf
  v_pk_mul_f32 v[70:71], v[70:71], v[58:59]
  v_pk_mul_f32 v[72:73], v[72:73], v[60:61]
  v_pk_mul_f32 v[74:75], v[74:75], v[62:63]
  v_add_f32_dpp v86, v86, v86 quad_perm:[2,3,0,1] row_mask:0xf bank_mask:0xf
  v_pk_mul_f32 v[76:77], v[76:77], v[64:65]
  v_pk_mul_f32 v[78:79], v[78:79], v[66:67]
  v_cndmask_b32 v91, v91, v86, s[52:53]
  s_waitcnt lgkmcnt(0)
  v_mfma_f32_16x16x32_bf16 v[44:47], a[72:75], v[8:11], 0
  v_exp_f32 v68, v68
  v_mfma_f32_16x16x32_bf16 v[48:51], a[72:75], v[20:23], 0
  buffer_load_dwordx4 v94, s[36:39], s67 offen offset:1024 lds
  v_exp_f32_e64 v69, v69
  v_mfma_f32_16x16x32_bf16 v[52:55], a[72:75], v[32:35], 0
  v_exp_f32_e64 v70, v70
  v_mfma_f32_16x16x32_bf16 v[44:47], a[76:79], v[12:15], v[44:47]
  v_exp_f32_e64 v71, v71
  v_mfma_f32_16x16x32_bf16 v[48:51], a[76:79], v[24:27], v[48:51]
  v_exp_f32_e64 v72, v72
  v_mfma_f32_16x16x32_bf16 v[52:55], a[76:79], v[36:39], v[52:55]
  v_exp_f32_e64 v73, v73
  v_mfma_f32_16x16x32_bf16 v[44:47], a[80:83], v[16:19], v[44:47]
  v_exp_f32_e64 v74, v74
  v_mfma_f32_16x16x32_bf16 v[48:51], a[80:83], v[28:31], v[48:51]
  v_exp_f32_e64 v75, v75
  v_mfma_f32_16x16x32_bf16 v[52:55], a[80:83], v[40:43], v[52:55]
  ds_read_b64_tr_b16 a[72:73], v4 offset:32
  ds_read_b64_tr_b16 a[74:75], v4 offset:12832
  ds_read_b64_tr_b16 a[76:77], v4 offset:25632
  ds_read_b64_tr_b16 a[78:79], v4 offset:38432
  ds_read_b64_tr_b16 a[80:81], v4 offset:51232
  ds_read_b64_tr_b16 a[82:83], v4 offset:64032
  v_exp_f32 v76, v76
  v_exp_f32 v77, v77
  v_exp_f32 v78, v78
  v_exp_f32 v79, v79
  v_pk_add_f32 v[68:69], v[68:69], 1.0 op_sel_hi:[1,0]
  v_pk_add_f32 v[70:71], v[70:71], 1.0 op_sel_hi:[1,0]
  v_pk_add_f32 v[72:73], v[72:73], 1.0 op_sel_hi:[1,0]
  v_pk_add_f32 v[74:75], v[74:75], 1.0 op_sel_hi:[1,0]
  v_pk_add_f32 v[76:77], v[76:77], 1.0 op_sel_hi:[1,0]
  v_pk_add_f32 v[78:79], v[78:79], 1.0 op_sel_hi:[1,0]
  v_rcp_f32 v68, v68
  v_rcp_f32 v69, v69
  v_rcp_f32 v70, v70
  v_rcp_f32 v71, v71
  v_rcp_f32 v72, v72
  v_rcp_f32 v73, v73
  v_rcp_f32 v74, v74
  v_rcp_f32 v75, v75
  v_rcp_f32 v76, v76
  v_rcp_f32 v77, v77
  v_rcp_f32 v78, v78
  v_rcp_f32 v79, v79
  v_pk_mul_f32 v[68:69], v[68:69], v[56:57]
  v_pk_mul_f32 v[70:71], v[70:71], v[58:59]
  v_pk_mul_f32 v[72:73], v[72:73], v[60:61]
  v_pk_mul_f32 v[74:75], v[74:75], v[62:63]
  v_pk_mul_f32 v[76:77], v[76:77], v[64:65]
  v_pk_mul_f32 v[78:79], v[78:79], v[66:67]
  v_pk_mul_f32 v[80:81], v[68:69], v[68:69]
  v_pk_mul_f32 v[82:83], v[70:71], v[70:71]
  v_pk_fma_f32 v[80:81], v[72:73], v[72:73], v[80:81]
  v_pk_fma_f32 v[82:83], v[74:75], v[74:75], v[82:83]
  v_pk_fma_f32 v[80:81], v[76:77], v[76:77], v[80:81]
  v_pk_fma_f32 v[82:83], v[78:79], v[78:79], v[82:83]
  v_cvt_pk_bf16_f32 v134, v68, v69
  v_cvt_pk_bf16_f32 v135, v70, v71
  v_cvt_pk_bf16_f32 v182, v72, v73
  v_cvt_pk_bf16_f32 v183, v74, v75
  v_cvt_pk_bf16_f32 v230, v76, v77
  v_cvt_pk_bf16_f32 v231, v78, v79
  v_pk_fma_f32 v[68:69], v[44:45], v[44:45], s[50:51]
  v_add_f32_dpp v84, v80, v80 row_ror:8 row_mask:0xf bank_mask:0x3
  v_add_f32_dpp v84, v81, v81 row_ror:8 row_mask:0xf bank_mask:0xc
  v_pk_fma_f32 v[70:71], v[46:47], v[46:47], s[50:51]
  v_add_f32_dpp v85, v82, v82 row_ror:8 row_mask:0xf bank_mask:0x3
  v_add_f32_dpp v85, v83, v83 row_ror:8 row_mask:0xf bank_mask:0xc
  v_pk_fma_f32 v[72:73], v[48:49], v[48:49], s[50:51]
  v_pk_fma_f32 v[74:75], v[50:51], v[50:51], s[50:51]
  v_add_f32_dpp v86, v84, v84 row_half_mirror row_mask:0xf bank_mask:0x5
  v_add_f32_dpp v86, v85, v85 row_half_mirror row_mask:0xf bank_mask:0xa
  v_pk_fma_f32 v[76:77], v[52:53], v[52:53], s[50:51]
  v_pk_fma_f32 v[78:79], v[54:55], v[54:55], s[50:51]
  v_pk_mul_f32 v[68:69], v[68:69], v[44:45]
  v_add_f32_dpp v86, v86, v86 quad_perm:[1,0,3,2] row_mask:0xf bank_mask:0xf
  v_pk_mul_f32 v[70:71], v[70:71], v[46:47]
  v_pk_mul_f32 v[72:73], v[72:73], v[48:49]
  v_pk_mul_f32 v[74:75], v[74:75], v[50:51]
  v_add_f32_dpp v86, v86, v86 quad_perm:[2,3,0,1] row_mask:0xf bank_mask:0xf
  v_pk_mul_f32 v[76:77], v[76:77], v[52:53]
  v_pk_mul_f32 v[78:79], v[78:79], v[54:55]
  v_cndmask_b32 v91, v91, v86, s[54:55]
  s_waitcnt lgkmcnt(0)
  v_mfma_f32_16x16x32_bf16 v[56:59], a[72:75], v[8:11], 0
  v_exp_f32 v68, v68
  v_mfma_f32_16x16x32_bf16 v[60:63], a[72:75], v[20:23], 0
  buffer_load_dwordx4 v95, s[36:39], s67 offen offset:2048 lds
  v_exp_f32_e64 v69, v69
  v_mfma_f32_16x16x32_bf16 v[64:67], a[72:75], v[32:35], 0
  v_exp_f32_e64 v70, v70
  v_mfma_f32_16x16x32_bf16 v[56:59], a[76:79], v[12:15], v[56:59]
  v_exp_f32_e64 v71, v71
  v_mfma_f32_16x16x32_bf16 v[60:63], a[76:79], v[24:27], v[60:63]
  v_exp_f32_e64 v72, v72
  v_mfma_f32_16x16x32_bf16 v[64:67], a[76:79], v[36:39], v[64:67]
  v_exp_f32_e64 v73, v73
  v_mfma_f32_16x16x32_bf16 v[56:59], a[80:83], v[16:19], v[56:59]
  v_exp_f32_e64 v74, v74
  v_mfma_f32_16x16x32_bf16 v[60:63], a[80:83], v[28:31], v[60:63]
  v_exp_f32_e64 v75, v75
  v_mfma_f32_16x16x32_bf16 v[64:67], a[80:83], v[40:43], v[64:67]
  ds_read_b64_tr_b16 a[72:73], v4 offset:64
  ds_read_b64_tr_b16 a[74:75], v4 offset:12864
  ds_read_b64_tr_b16 a[76:77], v4 offset:25664
  ds_read_b64_tr_b16 a[78:79], v4 offset:38464
  ds_read_b64_tr_b16 a[80:81], v4 offset:51264
  ds_read_b64_tr_b16 a[82:83], v4 offset:64064
  v_exp_f32 v76, v76
  v_exp_f32 v77, v77
  v_exp_f32 v78, v78
  v_exp_f32 v79, v79
  v_pk_add_f32 v[68:69], v[68:69], 1.0 op_sel_hi:[1,0]
  v_pk_add_f32 v[70:71], v[70:71], 1.0 op_sel_hi:[1,0]
  v_pk_add_f32 v[72:73], v[72:73], 1.0 op_sel_hi:[1,0]
  v_pk_add_f32 v[74:75], v[74:75], 1.0 op_sel_hi:[1,0]
  v_pk_add_f32 v[76:77], v[76:77], 1.0 op_sel_hi:[1,0]
  v_pk_add_f32 v[78:79], v[78:79], 1.0 op_sel_hi:[1,0]
  v_rcp_f32 v68, v68
  v_rcp_f32 v69, v69
  v_rcp_f32 v70, v70
  v_rcp_f32 v71, v71
  v_rcp_f32 v72, v72
  v_rcp_f32 v73, v73
  v_rcp_f32 v74, v74
  v_rcp_f32 v75, v75
  v_rcp_f32 v76, v76
  v_rcp_f32 v77, v77
  v_rcp_f32 v78, v78
  v_rcp_f32 v79, v79
  v_pk_mul_f32 v[68:69], v[68:69], v[44:45]
  v_pk_mul_f32 v[70:71], v[70:71], v[46:47]
  v_pk_mul_f32 v[72:73], v[72:73], v[48:49]
  v_pk_mul_f32 v[74:75], v[74:75], v[50:51]
  v_pk_mul_f32 v[76:77], v[76:77], v[52:53]
  v_pk_mul_f32 v[78:79], v[78:79], v[54:55]
  v_pk_mul_f32 v[80:81], v[68:69], v[68:69]
  v_pk_mul_f32 v[82:83], v[70:71], v[70:71]
  v_pk_fma_f32 v[80:81], v[72:73], v[72:73], v[80:81]
  v_pk_fma_f32 v[82:83], v[74:75], v[74:75], v[82:83]
  v_pk_fma_f32 v[80:81], v[76:77], v[76:77], v[80:81]
  v_pk_fma_f32 v[82:83], v[78:79], v[78:79], v[82:83]
  v_cvt_pk_bf16_f32 v136, v68, v69
  v_cvt_pk_bf16_f32 v137, v70, v71
  v_cvt_pk_bf16_f32 v184, v72, v73
  v_cvt_pk_bf16_f32 v185, v74, v75
  v_cvt_pk_bf16_f32 v232, v76, v77
  v_cvt_pk_bf16_f32 v233, v78, v79
  v_pk_fma_f32 v[68:69], v[56:57], v[56:57], s[50:51]
  v_add_f32_dpp v84, v80, v80 row_ror:8 row_mask:0xf bank_mask:0x3
  v_add_f32_dpp v84, v81, v81 row_ror:8 row_mask:0xf bank_mask:0xc
  v_pk_fma_f32 v[70:71], v[58:59], v[58:59], s[50:51]
  v_add_f32_dpp v85, v82, v82 row_ror:8 row_mask:0xf bank_mask:0x3
  v_add_f32_dpp v85, v83, v83 row_ror:8 row_mask:0xf bank_mask:0xc
  v_pk_fma_f32 v[72:73], v[60:61], v[60:61], s[50:51]
  v_pk_fma_f32 v[74:75], v[62:63], v[62:63], s[50:51]
  v_add_f32_dpp v86, v84, v84 row_half_mirror row_mask:0xf bank_mask:0x5
  v_add_f32_dpp v86, v85, v85 row_half_mirror row_mask:0xf bank_mask:0xa
  v_pk_fma_f32 v[76:77], v[64:65], v[64:65], s[50:51]
  v_pk_fma_f32 v[78:79], v[66:67], v[66:67], s[50:51]
  v_pk_mul_f32 v[68:69], v[68:69], v[56:57]
  v_add_f32_dpp v86, v86, v86 quad_perm:[1,0,3,2] row_mask:0xf bank_mask:0xf
  v_pk_mul_f32 v[70:71], v[70:71], v[58:59]
  v_pk_mul_f32 v[72:73], v[72:73], v[60:61]
  v_pk_mul_f32 v[74:75], v[74:75], v[62:63]
  v_add_f32_dpp v86, v86, v86 quad_perm:[2,3,0,1] row_mask:0xf bank_mask:0xf
  v_pk_mul_f32 v[76:77], v[76:77], v[64:65]
  v_pk_mul_f32 v[78:79], v[78:79], v[66:67]
  v_cndmask_b32 v91, v91, v86, s[56:57]
  s_waitcnt lgkmcnt(0)
  v_mfma_f32_16x16x32_bf16 v[44:47], a[72:75], v[8:11], 0
  v_exp_f32 v68, v68
  v_mfma_f32_16x16x32_bf16 v[48:51], a[72:75], v[20:23], 0
  v_exp_f32_e64 v69, v69
  v_mfma_f32_16x16x32_bf16 v[52:55], a[72:75], v[32:35], 0
  v_exp_f32_e64 v70, v70
  v_mfma_f32_16x16x32_bf16 v[44:47], a[76:79], v[12:15], v[44:47]
  v_exp_f32_e64 v71, v71
  v_mfma_f32_16x16x32_bf16 v[48:51], a[76:79], v[24:27], v[48:51]
  v_exp_f32_e64 v72, v72
  v_mfma_f32_16x16x32_bf16 v[52:55], a[76:79], v[36:39], v[52:55]
  v_exp_f32_e64 v73, v73
  v_mfma_f32_16x16x32_bf16 v[44:47], a[80:83], v[16:19], v[44:47]
  v_exp_f32_e64 v74, v74
  v_mfma_f32_16x16x32_bf16 v[48:51], a[80:83], v[28:31], v[48:51]
  v_exp_f32_e64 v75, v75
  v_mfma_f32_16x16x32_bf16 v[52:55], a[80:83], v[40:43], v[52:55]
  ds_read_b64_tr_b16 a[72:73], v4 offset:96
  ds_read_b64_tr_b16 a[74:75], v4 offset:12896
  ds_read_b64_tr_b16 a[76:77], v4 offset:25696
  ds_read_b64_tr_b16 a[78:79], v4 offset:38496
  ds_read_b64_tr_b16 a[80:81], v4 offset:51296
  ds_read_b64_tr_b16 a[82:83], v4 offset:64096
  v_exp_f32 v76, v76
  v_exp_f32 v77, v77
  v_exp_f32 v78, v78
  v_exp_f32 v79, v79
  v_pk_add_f32 v[68:69], v[68:69], 1.0 op_sel_hi:[1,0]
  v_pk_add_f32 v[70:71], v[70:71], 1.0 op_sel_hi:[1,0]
  v_pk_add_f32 v[72:73], v[72:73], 1.0 op_sel_hi:[1,0]
  v_pk_add_f32 v[74:75], v[74:75], 1.0 op_sel_hi:[1,0]
  v_pk_add_f32 v[76:77], v[76:77], 1.0 op_sel_hi:[1,0]
  v_pk_add_f32 v[78:79], v[78:79], 1.0 op_sel_hi:[1,0]
  v_rcp_f32 v68, v68
  v_rcp_f32 v69, v69
  v_rcp_f32 v70, v70
  v_rcp_f32 v71, v71
  v_rcp_f32 v72, v72
  v_rcp_f32 v73, v73
  v_rcp_f32 v74, v74
  v_rcp_f32 v75, v75
  v_rcp_f32 v76, v76
  v_rcp_f32 v77, v77
  v_rcp_f32 v78, v78
  v_rcp_f32 v79, v79
  v_pk_mul_f32 v[68:69], v[68:69], v[56:57]
  v_pk_mul_f32 v[70:71], v[70:71], v[58:59]
  v_pk_mul_f32 v[72:73], v[72:73], v[60:61]
  v_pk_mul_f32 v[74:75], v[74:75], v[62:63]
  v_pk_mul_f32 v[76:77], v[76:77], v[64:65]
  v_pk_mul_f32 v[78:79], v[78:79], v[66:67]
  v_pk_mul_f32 v[80:81], v[68:69], v[68:69]
  v_pk_mul_f32 v[82:83], v[70:71], v[70:71]
  v_pk_fma_f32 v[80:81], v[72:73], v[72:73], v[80:81]
  v_pk_fma_f32 v[82:83], v[74:75], v[74:75], v[82:83]
  v_pk_fma_f32 v[80:81], v[76:77], v[76:77], v[80:81]
  v_pk_fma_f32 v[82:83], v[78:79], v[78:79], v[82:83]
  v_cvt_pk_bf16_f32 v138, v68, v69
  v_cvt_pk_bf16_f32 v139, v70, v71
  v_cvt_pk_bf16_f32 v186, v72, v73
  v_cvt_pk_bf16_f32 v187, v74, v75
  v_cvt_pk_bf16_f32 v234, v76, v77
  v_cvt_pk_bf16_f32 v235, v78, v79
  v_pk_fma_f32 v[68:69], v[44:45], v[44:45], s[50:51]
  v_add_f32_dpp v84, v80, v80 row_ror:8 row_mask:0xf bank_mask:0x3
  v_add_f32_dpp v84, v81, v81 row_ror:8 row_mask:0xf bank_mask:0xc
  v_pk_fma_f32 v[70:71], v[46:47], v[46:47], s[50:51]
  v_add_f32_dpp v85, v82, v82 row_ror:8 row_mask:0xf bank_mask:0x3
  v_add_f32_dpp v85, v83, v83 row_ror:8 row_mask:0xf bank_mask:0xc
  v_pk_fma_f32 v[72:73], v[48:49], v[48:49], s[50:51]
  v_pk_fma_f32 v[74:75], v[50:51], v[50:51], s[50:51]
  v_add_f32_dpp v86, v84, v84 row_half_mirror row_mask:0xf bank_mask:0x5
  v_add_f32_dpp v86, v85, v85 row_half_mirror row_mask:0xf bank_mask:0xa
  v_pk_fma_f32 v[76:77], v[52:53], v[52:53], s[50:51]
  v_pk_fma_f32 v[78:79], v[54:55], v[54:55], s[50:51]
  v_pk_mul_f32 v[68:69], v[68:69], v[44:45]
  v_add_f32_dpp v86, v86, v86 quad_perm:[1,0,3,2] row_mask:0xf bank_mask:0xf
  v_pk_mul_f32 v[70:71], v[70:71], v[46:47]
  v_pk_mul_f32 v[72:73], v[72:73], v[48:49]
  v_pk_mul_f32 v[74:75], v[74:75], v[50:51]
  v_add_f32_dpp v86, v86, v86 quad_perm:[2,3,0,1] row_mask:0xf bank_mask:0xf
  v_pk_mul_f32 v[76:77], v[76:77], v[52:53]
  v_pk_mul_f32 v[78:79], v[78:79], v[54:55]
  v_cndmask_b32 v91, v91, v86, s[58:59]
  s_waitcnt lgkmcnt(0)
  v_mfma_f32_16x16x32_bf16 v[56:59], a[72:75], v[8:11], 0
  v_exp_f32 v68, v68
  v_mfma_f32_16x16x32_bf16 v[60:63], a[72:75], v[20:23], 0
  v_exp_f32_e64 v69, v69
  v_mfma_f32_16x16x32_bf16 v[64:67], a[72:75], v[32:35], 0
  v_exp_f32_e64 v70, v70
  v_mfma_f32_16x16x32_bf16 v[56:59], a[76:79], v[12:15], v[56:59]
  v_exp_f32_e64 v71, v71
  v_mfma_f32_16x16x32_bf16 v[60:63], a[76:79], v[24:27], v[60:63]
  v_exp_f32_e64 v72, v72
  v_mfma_f32_16x16x32_bf16 v[64:67], a[76:79], v[36:39], v[64:67]
  v_exp_f32_e64 v73, v73
  v_mfma_f32_16x16x32_bf16 v[56:59], a[80:83], v[16:19], v[56:59]
  v_exp_f32_e64 v74, v74
  v_mfma_f32_16x16x32_bf16 v[60:63], a[80:83], v[28:31], v[60:63]
  v_exp_f32_e64 v75, v75
  v_mfma_f32_16x16x32_bf16 v[64:67], a[80:83], v[40:43], v[64:67]
  ds_read_b64_tr_b16 a[72:73], v4 offset:128
  ds_read_b64_tr_b16 a[74:75], v4 offset:12928
  ds_read_b64_tr_b16 a[76:77], v4 offset:25728
  ds_read_b64_tr_b16 a[78:79], v4 offset:38528
  ds_read_b64_tr_b16 a[80:81], v4 offset:51328
  ds_read_b64_tr_b16 a[82:83], v4 offset:64128
  v_exp_f32 v76, v76
  v_exp_f32 v77, v77
  v_exp_f32 v78, v78
  v_exp_f32 v79, v79
  v_pk_add_f32 v[68:69], v[68:69], 1.0 op_sel_hi:[1,0]
  v_pk_add_f32 v[70:71], v[70:71], 1.0 op_sel_hi:[1,0]
  v_pk_add_f32 v[72:73], v[72:73], 1.0 op_sel_hi:[1,0]
  v_pk_add_f32 v[74:75], v[74:75], 1.0 op_sel_hi:[1,0]
  v_pk_add_f32 v[76:77], v[76:77], 1.0 op_sel_hi:[1,0]
  v_pk_add_f32 v[78:79], v[78:79], 1.0 op_sel_hi:[1,0]
  v_rcp_f32 v68, v68
  v_rcp_f32 v69, v69
  v_rcp_f32 v70, v70
  v_rcp_f32 v71, v71
  v_rcp_f32 v72, v72
  v_rcp_f32 v73, v73
  v_rcp_f32 v74, v74
  v_rcp_f32 v75, v75
  v_rcp_f32 v76, v76
  v_rcp_f32 v77, v77
  v_rcp_f32 v78, v78
  v_rcp_f32 v79, v79
  v_pk_mul_f32 v[68:69], v[68:69], v[44:45]
  v_pk_mul_f32 v[70:71], v[70:71], v[46:47]
  v_pk_mul_f32 v[72:73], v[72:73], v[48:49]
  v_pk_mul_f32 v[74:75], v[74:75], v[50:51]
  v_pk_mul_f32 v[76:77], v[76:77], v[52:53]
  v_pk_mul_f32 v[78:79], v[78:79], v[54:55]
  v_pk_mul_f32 v[80:81], v[68:69], v[68:69]
  v_pk_mul_f32 v[82:83], v[70:71], v[70:71]
  v_pk_fma_f32 v[80:81], v[72:73], v[72:73], v[80:81]
  v_pk_fma_f32 v[82:83], v[74:75], v[74:75], v[82:83]
  v_pk_fma_f32 v[80:81], v[76:77], v[76:77], v[80:81]
  v_pk_fma_f32 v[82:83], v[78:79], v[78:79], v[82:83]
  v_cvt_pk_bf16_f32 v140, v68, v69
  v_cvt_pk_bf16_f32 v141, v70, v71
  v_cvt_pk_bf16_f32 v188, v72, v73
  v_cvt_pk_bf16_f32 v189, v74, v75
  v_cvt_pk_bf16_f32 v236, v76, v77
  v_cvt_pk_bf16_f32 v237, v78, v79
  v_pk_fma_f32 v[68:69], v[56:57], v[56:57], s[50:51]
  v_add_f32_dpp v84, v80, v80 row_ror:8 row_mask:0xf bank_mask:0x3
  v_add_f32_dpp v84, v81, v81 row_ror:8 row_mask:0xf bank_mask:0xc
  v_pk_fma_f32 v[70:71], v[58:59], v[58:59], s[50:51]
  v_add_f32_dpp v85, v82, v82 row_ror:8 row_mask:0xf bank_mask:0x3
  v_add_f32_dpp v85, v83, v83 row_ror:8 row_mask:0xf bank_mask:0xc
  v_pk_fma_f32 v[72:73], v[60:61], v[60:61], s[50:51]
  v_pk_fma_f32 v[74:75], v[62:63], v[62:63], s[50:51]
  v_add_f32_dpp v86, v84, v84 row_half_mirror row_mask:0xf bank_mask:0x5
  v_add_f32_dpp v86, v85, v85 row_half_mirror row_mask:0xf bank_mask:0xa
  v_pk_fma_f32 v[76:77], v[64:65], v[64:65], s[50:51]
  v_pk_fma_f32 v[78:79], v[66:67], v[66:67], s[50:51]
  v_pk_mul_f32 v[68:69], v[68:69], v[56:57]
  v_add_f32_dpp v86, v86, v86 quad_perm:[1,0,3,2] row_mask:0xf bank_mask:0xf
  v_pk_mul_f32 v[70:71], v[70:71], v[58:59]
  v_pk_mul_f32 v[72:73], v[72:73], v[60:61]
  v_pk_mul_f32 v[74:75], v[74:75], v[62:63]
  v_add_f32_dpp v86, v86, v86 quad_perm:[2,3,0,1] row_mask:0xf bank_mask:0xf
  v_pk_mul_f32 v[76:77], v[76:77], v[64:65]
  v_pk_mul_f32 v[78:79], v[78:79], v[66:67]
  v_cndmask_b32 v92, v92, v86, s[52:53]
  s_waitcnt lgkmcnt(0)
  v_mfma_f32_16x16x32_bf16 v[44:47], a[72:75], v[8:11], 0
  v_exp_f32 v68, v68
  v_mfma_f32_16x16x32_bf16 v[48:51], a[72:75], v[20:23], 0
  v_exp_f32_e64 v69, v69
  v_mfma_f32_16x16x32_bf16 v[52:55], a[72:75], v[32:35], 0
  v_exp_f32_e64 v70, v70
  v_mfma_f32_16x16x32_bf16 v[44:47], a[76:79], v[12:15], v[44:47]
  v_exp_f32_e64 v71, v71
  v_mfma_f32_16x16x32_bf16 v[48:51], a[76:79], v[24:27], v[48:51]
  v_exp_f32_e64 v72, v72
  v_mfma_f32_16x16x32_bf16 v[52:55], a[76:79], v[36:39], v[52:55]
  v_exp_f32_e64 v73, v73
  v_mfma_f32_16x16x32_bf16 v[44:47], a[80:83], v[16:19], v[44:47]
  v_exp_f32_e64 v74, v74
  v_mfma_f32_16x16x32_bf16 v[48:51], a[80:83], v[28:31], v[48:51]
  v_exp_f32_e64 v75, v75
  v_mfma_f32_16x16x32_bf16 v[52:55], a[80:83], v[40:43], v[52:55]
  ds_read_b64_tr_b16 a[72:73], v4 offset:160
  ds_read_b64_tr_b16 a[74:75], v4 offset:12960
  ds_read_b64_tr_b16 a[76:77], v4 offset:25760
  ds_read_b64_tr_b16 a[78:79], v4 offset:38560
  ds_read_b64_tr_b16 a[80:81], v4 offset:51360
  ds_read_b64_tr_b16 a[82:83], v4 offset:64160
  v_exp_f32 v76, v76
  v_exp_f32 v77, v77
  v_exp_f32 v78, v78
  v_exp_f32 v79, v79
  v_pk_add_f32 v[68:69], v[68:69], 1.0 op_sel_hi:[1,0]
  v_pk_add_f32 v[70:71], v[70:71], 1.0 op_sel_hi:[1,0]
  v_pk_add_f32 v[72:73], v[72:73], 1.0 op_sel_hi:[1,0]
  v_pk_add_f32 v[74:75], v[74:75], 1.0 op_sel_hi:[1,0]
  v_pk_add_f32 v[76:77], v[76:77], 1.0 op_sel_hi:[1,0]
  v_pk_add_f32 v[78:79], v[78:79], 1.0 op_sel_hi:[1,0]
  v_rcp_f32 v68, v68
  v_rcp_f32 v69, v69
  v_rcp_f32 v70, v70
  v_rcp_f32 v71, v71
  v_rcp_f32 v72, v72
  v_rcp_f32 v73, v73
  v_rcp_f32 v74, v74
  v_rcp_f32 v75, v75
  v_rcp_f32 v76, v76
  v_rcp_f32 v77, v77
  v_rcp_f32 v78, v78
  v_rcp_f32 v79, v79
  v_pk_mul_f32 v[68:69], v[68:69], v[56:57]
  v_pk_mul_f32 v[70:71], v[70:71], v[58:59]
  v_pk_mul_f32 v[72:73], v[72:73], v[60:61]
  v_pk_mul_f32 v[74:75], v[74:75], v[62:63]
  v_pk_mul_f32 v[76:77], v[76:77], v[64:65]
  v_pk_mul_f32 v[78:79], v[78:79], v[66:67]
  v_pk_mul_f32 v[80:81], v[68:69], v[68:69]
  v_pk_mul_f32 v[82:83], v[70:71], v[70:71]
  v_pk_fma_f32 v[80:81], v[72:73], v[72:73], v[80:81]
  v_pk_fma_f32 v[82:83], v[74:75], v[74:75], v[82:83]
  v_pk_fma_f32 v[80:81], v[76:77], v[76:77], v[80:81]
  v_pk_fma_f32 v[82:83], v[78:79], v[78:79], v[82:83]
  v_cvt_pk_bf16_f32 v142, v68, v69
  v_cvt_pk_bf16_f32 v143, v70, v71
  v_cvt_pk_bf16_f32 v190, v72, v73
  v_cvt_pk_bf16_f32 v191, v74, v75
  v_cvt_pk_bf16_f32 v238, v76, v77
  v_cvt_pk_bf16_f32 v239, v78, v79
  v_pk_fma_f32 v[68:69], v[44:45], v[44:45], s[50:51]
  v_add_f32_dpp v84, v80, v80 row_ror:8 row_mask:0xf bank_mask:0x3
  v_add_f32_dpp v84, v81, v81 row_ror:8 row_mask:0xf bank_mask:0xc
  v_pk_fma_f32 v[70:71], v[46:47], v[46:47], s[50:51]
  v_add_f32_dpp v85, v82, v82 row_ror:8 row_mask:0xf bank_mask:0x3
  v_add_f32_dpp v85, v83, v83 row_ror:8 row_mask:0xf bank_mask:0xc
  v_pk_fma_f32 v[72:73], v[48:49], v[48:49], s[50:51]
  v_pk_fma_f32 v[74:75], v[50:51], v[50:51], s[50:51]
  v_add_f32_dpp v86, v84, v84 row_half_mirror row_mask:0xf bank_mask:0x5
  v_add_f32_dpp v86, v85, v85 row_half_mirror row_mask:0xf bank_mask:0xa
  v_pk_fma_f32 v[76:77], v[52:53], v[52:53], s[50:51]
  v_pk_fma_f32 v[78:79], v[54:55], v[54:55], s[50:51]
  v_pk_mul_f32 v[68:69], v[68:69], v[44:45]
  v_add_f32_dpp v86, v86, v86 quad_perm:[1,0,3,2] row_mask:0xf bank_mask:0xf
  v_pk_mul_f32 v[70:71], v[70:71], v[46:47]
  v_pk_mul_f32 v[72:73], v[72:73], v[48:49]
  v_pk_mul_f32 v[74:75], v[74:75], v[50:51]
  v_add_f32_dpp v86, v86, v86 quad_perm:[2,3,0,1] row_mask:0xf bank_mask:0xf
  v_pk_mul_f32 v[76:77], v[76:77], v[52:53]
  v_pk_mul_f32 v[78:79], v[78:79], v[54:55]
  v_cndmask_b32 v92, v92, v86, s[54:55]
  s_waitcnt lgkmcnt(0)
  v_mfma_f32_16x16x32_bf16 v[56:59], a[72:75], v[8:11], 0
  v_exp_f32 v68, v68
  v_mfma_f32_16x16x32_bf16 v[60:63], a[72:75], v[20:23], 0
  v_exp_f32_e64 v69, v69
  v_mfma_f32_16x16x32_bf16 v[64:67], a[72:75], v[32:35], 0
  v_exp_f32_e64 v70, v70
  v_mfma_f32_16x16x32_bf16 v[56:59], a[76:79], v[12:15], v[56:59]
  v_exp_f32_e64 v71, v71
  v_mfma_f32_16x16x32_bf16 v[60:63], a[76:79], v[24:27], v[60:63]
  v_exp_f32_e64 v72, v72
  v_mfma_f32_16x16x32_bf16 v[64:67], a[76:79], v[36:39], v[64:67]
  v_exp_f32_e64 v73, v73
  v_mfma_f32_16x16x32_bf16 v[56:59], a[80:83], v[16:19], v[56:59]
  v_exp_f32_e64 v74, v74
  v_mfma_f32_16x16x32_bf16 v[60:63], a[80:83], v[28:31], v[60:63]
  v_exp_f32_e64 v75, v75
  v_mfma_f32_16x16x32_bf16 v[64:67], a[80:83], v[40:43], v[64:67]
  v_exp_f32 v76, v76
  v_exp_f32 v77, v77
  v_exp_f32 v78, v78
  v_exp_f32 v79, v79
  v_pk_add_f32 v[68:69], v[68:69], 1.0 op_sel_hi:[1,0]
  v_pk_add_f32 v[70:71], v[70:71], 1.0 op_sel_hi:[1,0]
  v_pk_add_f32 v[72:73], v[72:73], 1.0 op_sel_hi:[1,0]
  v_pk_add_f32 v[74:75], v[74:75], 1.0 op_sel_hi:[1,0]
  v_pk_add_f32 v[76:77], v[76:77], 1.0 op_sel_hi:[1,0]
  v_pk_add_f32 v[78:79], v[78:79], 1.0 op_sel_hi:[1,0]
  v_rcp_f32 v68, v68
  v_rcp_f32 v69, v69
  v_rcp_f32 v70, v70
  v_rcp_f32 v71, v71
  v_rcp_f32 v72, v72
  v_rcp_f32 v73, v73
  v_rcp_f32 v74, v74
  v_rcp_f32 v75, v75
  v_rcp_f32 v76, v76
  v_rcp_f32 v77, v77
  v_rcp_f32 v78, v78
  v_rcp_f32 v79, v79
  v_pk_mul_f32 v[68:69], v[68:69], v[44:45]
  v_pk_mul_f32 v[70:71], v[70:71], v[46:47]
  v_pk_mul_f32 v[72:73], v[72:73], v[48:49]
  v_pk_mul_f32 v[74:75], v[74:75], v[50:51]
  v_pk_mul_f32 v[76:77], v[76:77], v[52:53]
  v_pk_mul_f32 v[78:79], v[78:79], v[54:55]
  v_pk_mul_f32 v[80:81], v[68:69], v[68:69]
  v_pk_mul_f32 v[82:83], v[70:71], v[70:71]
  v_pk_fma_f32 v[80:81], v[72:73], v[72:73], v[80:81]
  v_pk_fma_f32 v[82:83], v[74:75], v[74:75], v[82:83]
  v_pk_fma_f32 v[80:81], v[76:77], v[76:77], v[80:81]
  v_pk_fma_f32 v[82:83], v[78:79], v[78:79], v[82:83]
  v_cvt_pk_bf16_f32 v144, v68, v69
  v_cvt_pk_bf16_f32 v145, v70, v71
  v_cvt_pk_bf16_f32 v192, v72, v73
  v_cvt_pk_bf16_f32 v193, v74, v75
  v_cvt_pk_bf16_f32 v240, v76, v77
  v_cvt_pk_bf16_f32 v241, v78, v79
  v_pk_fma_f32 v[68:69], v[56:57], v[56:57], s[50:51]
  v_add_f32_dpp v84, v80, v80 row_ror:8 row_mask:0xf bank_mask:0x3
  v_add_f32_dpp v84, v81, v81 row_ror:8 row_mask:0xf bank_mask:0xc
  v_pk_fma_f32 v[70:71], v[58:59], v[58:59], s[50:51]
  v_add_f32_dpp v85, v82, v82 row_ror:8 row_mask:0xf bank_mask:0x3
  v_add_f32_dpp v85, v83, v83 row_ror:8 row_mask:0xf bank_mask:0xc
  v_pk_fma_f32 v[72:73], v[60:61], v[60:61], s[50:51]
  v_pk_fma_f32 v[74:75], v[62:63], v[62:63], s[50:51]
  v_add_f32_dpp v86, v84, v84 row_half_mirror row_mask:0xf bank_mask:0x5
  v_add_f32_dpp v86, v85, v85 row_half_mirror row_mask:0xf bank_mask:0xa
  v_pk_fma_f32 v[76:77], v[64:65], v[64:65], s[50:51]
  v_pk_fma_f32 v[78:79], v[66:67], v[66:67], s[50:51]
  v_pk_mul_f32 v[68:69], v[68:69], v[56:57]
  v_add_f32_dpp v86, v86, v86 quad_perm:[1,0,3,2] row_mask:0xf bank_mask:0xf
  v_pk_mul_f32 v[70:71], v[70:71], v[58:59]
  v_pk_mul_f32 v[72:73], v[72:73], v[60:61]
  v_pk_mul_f32 v[74:75], v[74:75], v[62:63]
  v_add_f32_dpp v86, v86, v86 quad_perm:[2,3,0,1] row_mask:0xf bank_mask:0xf
  v_pk_mul_f32 v[76:77], v[76:77], v[64:65]
  v_pk_mul_f32 v[78:79], v[78:79], v[66:67]
  v_cndmask_b32 v92, v92, v86, s[56:57]
  v_exp_f32 v68, v68
  v_exp_f32 v69, v69
  v_exp_f32 v70, v70
  v_exp_f32 v71, v71
  v_exp_f32 v72, v72
  v_exp_f32 v73, v73
  v_exp_f32 v74, v74
  v_exp_f32 v75, v75
  v_exp_f32 v76, v76
  v_exp_f32 v77, v77
  v_exp_f32 v78, v78
  v_exp_f32 v79, v79
  v_pk_add_f32 v[68:69], v[68:69], 1.0 op_sel_hi:[1,0]
  v_pk_add_f32 v[70:71], v[70:71], 1.0 op_sel_hi:[1,0]
  v_pk_add_f32 v[72:73], v[72:73], 1.0 op_sel_hi:[1,0]
  v_pk_add_f32 v[74:75], v[74:75], 1.0 op_sel_hi:[1,0]
  v_pk_add_f32 v[76:77], v[76:77], 1.0 op_sel_hi:[1,0]
  v_pk_add_f32 v[78:79], v[78:79], 1.0 op_sel_hi:[1,0]
  v_rcp_f32 v68, v68
  v_rcp_f32 v69, v69
  v_rcp_f32 v70, v70
  v_rcp_f32 v71, v71
  v_rcp_f32 v72, v72
  v_rcp_f32 v73, v73
  v_rcp_f32 v74, v74
  v_rcp_f32 v75, v75
  v_rcp_f32 v76, v76
  v_rcp_f32 v77, v77
  v_rcp_f32 v78, v78
  v_rcp_f32 v79, v79
  v_pk_mul_f32 v[68:69], v[68:69], v[56:57]
  v_pk_mul_f32 v[70:71], v[70:71], v[58:59]
  v_pk_mul_f32 v[72:73], v[72:73], v[60:61]
  v_pk_mul_f32 v[74:75], v[74:75], v[62:63]
  v_pk_mul_f32 v[76:77], v[76:77], v[64:65]
  v_pk_mul_f32 v[78:79], v[78:79], v[66:67]
  v_pk_mul_f32 v[80:81], v[68:69], v[68:69]
  v_pk_mul_f32 v[82:83], v[70:71], v[70:71]
  v_pk_fma_f32 v[80:81], v[72:73], v[72:73], v[80:81]
  v_pk_fma_f32 v[82:83], v[74:75], v[74:75], v[82:83]
  v_pk_fma_f32 v[80:81], v[76:77], v[76:77], v[80:81]
  v_pk_fma_f32 v[82:83], v[78:79], v[78:79], v[82:83]
  v_cvt_pk_bf16_f32 v146, v68, v69
  v_cvt_pk_bf16_f32 v147, v70, v71
  v_cvt_pk_bf16_f32 v194, v72, v73
  v_cvt_pk_bf16_f32 v195, v74, v75
  v_cvt_pk_bf16_f32 v242, v76, v77
  v_cvt_pk_bf16_f32 v243, v78, v79
  v_add_f32_dpp v84, v80, v80 row_ror:8 row_mask:0xf bank_mask:0x3
  v_add_f32_dpp v84, v81, v81 row_ror:8 row_mask:0xf bank_mask:0xc
  v_add_f32_dpp v85, v82, v82 row_ror:8 row_mask:0xf bank_mask:0x3
  v_add_f32_dpp v85, v83, v83 row_ror:8 row_mask:0xf bank_mask:0xc
  v_add_f32_dpp v86, v84, v84 row_half_mirror row_mask:0xf bank_mask:0x5
  s_nop 0
  v_add_f32_dpp v86, v85, v85 row_half_mirror row_mask:0xf bank_mask:0xa
  s_nop 1
  v_add_f32_dpp v86, v86, v86 quad_perm:[1,0,3,2] row_mask:0xf bank_mask:0xf
  s_nop 1
  v_add_f32_dpp v86, v86, v86 quad_perm:[2,3,0,1] row_mask:0xf bank_mask:0xf
  v_cndmask_b32 v92, v92, v86, s[58:59]
  s_waitcnt vmcnt(0)
  v_accvgpr_read_b32 v72, a24
  v_accvgpr_read_b32 v73, a25
  v_accvgpr_read_b32 v74, a26
  v_accvgpr_read_b32 v75, a27
  v_accvgpr_read_b32 v76, a28
  v_accvgpr_read_b32 v77, a29
  v_accvgpr_read_b32 v68, a30
  v_accvgpr_read_b32 v69, a31
  ds_write_b32 v72, v87
  ds_write_b32 v73, v88
  ds_write_b32 v74, v89
  ds_write_b32 v75, v90
  ds_write_b32 v76, v91
  ds_write_b32 v77, v92
  s_add_u32 s47, s47, 0x9e3779b1
  s_cmp_eq_u32 s47, 0
  s_cselect_b32 s66, 0x9e3779b1, 0
  s_add_u32 s47, s47, s66
  s_waitcnt lgkmcnt(0)
  s_barrier
  s_cmp_ge_u32 s44, 2
  s_cbranch_scc1 L_nopub
  ds_read2st64_b32 v[44:45], v68 offset0:0 offset1:2
  ds_read2st64_b32 v[46:47], v68 offset0:6 offset1:8
  ds_read2st64_b32 v[48:49], v68 offset0:12 offset1:14
  ds_read2st64_b32 v[50:51], v68 offset0:18 offset1:20
  ds_read2st64_b32 v[52:53], v68 offset0:4 offset1:10
  ds_read2st64_b32 v[54:55], v68 offset0:16 offset1:22
  v_mov_b32 v75, s47
  s_waitcnt lgkmcnt(0)
  v_add_f32 v72, v44, v46
  v_add_f32 v73, v45, v47
  v_add_f32 v74, v52, v53
  v_add_f32 v48, v48, v50
  v_add_f32 v49, v49, v51
  v_add_f32 v54, v54, v55
  v_add_f32 v72, v72, v48
  v_add_f32 v73, v73, v49
  v_add_f32_e64 v74, v74, v54
  global_store_dwordx4 v69, v[72:75], s[20:21] sc1
L_nopub:
  v_accvgpr_read_b32 v50, a21
  v_accvgpr_read_b32 v51, a22
  v_accvgpr_read_b32 v53, a23
  ds_read_b64 a[72:73], v51 offset:0
  ds_read_b64 a[74:75], v51 offset:32
  ds_read_b64 a[76:77], v51 offset:64
  ds_read_b64 a[78:79], v51 offset:96
  ds_read_b64 a[80:81], v51 offset:128
  ds_read_b64 a[82:83], v51 offset:160
  ds_read_u16 v80, v53 offset:0
  ds_read_u16 v81, v53 offset:256
  ds_read_u16 v82, v53 offset:512
  ds_read_u16 v83, v53 offset:128
  ds_read_u16 v84, v53 offset:384
  ds_read_u16 v85, v53 offset:640
  v_accvgpr_read_b32 v95, a14
  v_accvgpr_read_b32 v96, a15
  v_accvgpr_read_b32 v97, a16
  v_accvgpr_read_b32 v98, a17
  v_accvgpr_read_b32 v99, a18
  v_accvgpr_read_b32 v5, a19
  v_accvgpr_read_b32 v6, a20
  v_accvgpr_read_b32 v54, a11
  v_accvgpr_write_b32 a96, v54
  v_accvgpr_read_b32 v55, a12
  v_accvgpr_write_b32 a97, v55
  v_accvgpr_read_b32 v56, a13
  v_accvgpr_write_b32 a98, v56
  ds_read_b128 a[0:3], v50 offset:0
  ds_read_b128 a[4:7], v50 offset:3072
  ds_read_b128 a[8:11], v50 offset:6144
  s_waitcnt lgkmcnt(13)
  ds_read_b128 a[12:15], v50 offset:9216
  ds_read_b128 a[16:19], v50 offset:12288
  s_waitcnt lgkmcnt(13)
  ds_read_b128 a[20:23], v50 offset:15360
  ds_read_b128 a[24:27], v50 offset:64
  s_waitcnt lgkmcnt(13)
  s_nop 0
  ds_read_b128 a[28:31], v50 offset:3136
  v_accvgpr_write_b32 a100, v100
  v_accvgpr_write_b32 a101, v101
  v_accvgpr_write_b32 a102, v102
  v_accvgpr_write_b32 a103, v103
  v_accvgpr_write_b32 a104, v104
  v_accvgpr_write_b32 a105, v105
  v_accvgpr_write_b32 a106, v106
  v_accvgpr_write_b32 a107, v107
  v_accvgpr_write_b32 a108, v108
  v_accvgpr_write_b32 a109, v109
  v_accvgpr_write_b32 a110, v110
  v_accvgpr_write_b32 a111, v111
  v_accvgpr_write_b32 a112, v112
  v_accvgpr_write_b32 a113, v113
  v_accvgpr_write_b32 a114, v114
  v_accvgpr_write_b32 a115, v115
  v_accvgpr_write_b32 a116, v116
  v_accvgpr_write_b32 a117, v117
  v_accvgpr_write_b32 a118, v118
  v_accvgpr_write_b32 a119, v119
  v_accvgpr_write_b32 a120, v120
  v_accvgpr_write_b32 a121, v121
  v_accvgpr_write_b32 a122, v122
  v_accvgpr_write_b32 a123, v123
  v_accvgpr_write_b32 a124, v124
  v_accvgpr_write_b32 a125, v125
  v_accvgpr_write_b32 a126, v126
  v_accvgpr_write_b32 a127, v127
  v_accvgpr_write_b32 a128, v128
  v_accvgpr_write_b32 a129, v129
  v_accvgpr_write_b32 a130, v130
  v_accvgpr_write_b32 a131, v131
  v_accvgpr_write_b32 a132, v132
  v_accvgpr_write_b32 a133, v133
  v_accvgpr_write_b32 a134, v134
  v_accvgpr_write_b32 a135, v135
  v_accvgpr_write_b32 a136, v136
  v_accvgpr_write_b32 a137, v137
  v_accvgpr_write_b32 a138, v138
  v_accvgpr_write_b32 a139, v139
  v_accvgpr_write_b32 a140, v140
  v_accvgpr_write_b32 a141, v141
  v_accvgpr_write_b32 a142, v142
  v_accvgpr_write_b32 a143, v143
  v_accvgpr_write_b32 a144, v144
  v_accvgpr_write_b32 a145, v145
  v_accvgpr_write_b32 a146, v146
  v_accvgpr_write_b32 a147, v147
  v_accvgpr_write_b32 a148, v148
  v_accvgpr_write_b32 a149, v149
  v_accvgpr_write_b32 a150, v150
  v_accvgpr_write_b32 a151, v151
  v_accvgpr_write_b32 a152, v152
  v_accvgpr_write_b32 a153, v153
  v_accvgpr_write_b32 a154, v154
  v_accvgpr_write_b32 a155, v155
  v_accvgpr_write_b32 a156, v156
  v_accvgpr_write_b32 a157, v157
  v_accvgpr_write_b32 a158, v158
  v_accvgpr_write_b32 a159, v159
  v_accvgpr_write_b32 a160, v160
  v_accvgpr_write_b32 a161, v161
  v_accvgpr_write_b32 a162, v162
  v_accvgpr_write_b32 a163, v163
  v_accvgpr_write_b32 a164, v164
  v_accvgpr_write_b32 a165, v165
  v_accvgpr_write_b32 a166, v166
  v_accvgpr_write_b32 a167, v167
  v_accvgpr_write_b32 a168, v168
  v_accvgpr_write_b32 a169, v169
  v_accvgpr_write_b32 a170, v170
  v_accvgpr_write_b32 a171, v171
  v_accvgpr_write_b32 a172, v172
  v_accvgpr_write_b32 a173, v173
  v_accvgpr_write_b32 a174, v174
  v_accvgpr_write_b32 a175, v175
  v_accvgpr_write_b32 a176, v176
  v_accvgpr_write_b32 a177, v177
  v_accvgpr_write_b32 a178, v178
  v_accvgpr_write_b32 a179, v179
  v_accvgpr_write_b32 a180, v180
  v_accvgpr_write_b32 a181, v181
  v_accvgpr_write_b32 a182, v182
  v_accvgpr_write_b32 a183, v183
  v_accvgpr_write_b32 a184, v184
  v_accvgpr_write_b32 a185, v185
  v_accvgpr_write_b32 a186, v186
  v_accvgpr_write_b32 a187, v187
  v_accvgpr_write_b32 a188, v188
  v_accvgpr_write_b32 a189, v189
  v_accvgpr_write_b32 a190, v190
  v_accvgpr_write_b32 a191, v191
  v_accvgpr_write_b32 a192, v192
  v_accvgpr_write_b32 a193, v193
  v_accvgpr_write_b32 a194, v194
  v_accvgpr_write_b32 a195, v195
  v_accvgpr_write_b32 a196, v196
  v_accvgpr_write_b32 a197, v197
  v_accvgpr_write_b32 a198, v198
  v_accvgpr_write_b32 a199, v199
  v_accvgpr_write_b32 a200, v200
  v_accvgpr_write_b32 a201, v201
  v_accvgpr_write_b32 a202, v202
  v_accvgpr_write_b32 a203, v203
  v_accvgpr_write_b32 a204, v204
  v_accvgpr_write_b32 a205, v205
  v_accvgpr_write_b32 a206, v206
  v_accvgpr_write_b32 a207, v207
  v_accvgpr_write_b32 a208, v208
  v_accvgpr_write_b32 a209, v209
  v_accvgpr_write_b32 a210, v210
  v_accvgpr_write_b32 a211, v211
  v_accvgpr_write_b32 a212, v212
  v_accvgpr_write_b32 a213, v213
  v_accvgpr_write_b32 a214, v214
  v_accvgpr_write_b32 a215, v215
  v_accvgpr_write_b32 a216, v216
  v_accvgpr_write_b32 a217, v217
  v_accvgpr_write_b32 a218, v218
  v_accvgpr_write_b32 a219, v219
  v_accvgpr_write_b32 a220, v220
  v_accvgpr_write_b32 a221, v221
  v_accvgpr_write_b32 a222, v222
  v_accvgpr_write_b32 a223, v223
  v_accvgpr_write_b32 a224, v224
  v_accvgpr_write_b32 a225, v225
  v_accvgpr_write_b32 a226, v226
  v_accvgpr_write_b32 a227, v227
  v_accvgpr_write_b32 a228, v228
  v_accvgpr_write_b32 a229, v229
  v_accvgpr_write_b32 a230, v230
  v_accvgpr_write_b32 a231, v231
  v_accvgpr_write_b32 a232, v232
  v_accvgpr_write_b32 a233, v233
  v_accvgpr_write_b32 a234, v234
  v_accvgpr_write_b32 a235, v235
  v_accvgpr_write_b32 a236, v236
  v_accvgpr_write_b32 a237, v237
  v_accvgpr_write_b32 a238, v238
  v_accvgpr_write_b32 a239, v239
  v_accvgpr_write_b32 a240, v240
  v_accvgpr_write_b32 a241, v241
  v_accvgpr_write_b32 a242, v242
  v_accvgpr_write_b32 a243, v243
  v_accvgpr_write_b32 a244, v244
  v_accvgpr_write_b32 a245, v245
  v_accvgpr_write_b32 a246, v246
  v_accvgpr_write_b32 a247, v247
  v_accvgpr_write_b32 a248, v248
  v_accvgpr_write_b32 a249, v249
  v_accvgpr_write_b32 a250, v250
  v_accvgpr_write_b32 a251, v251
  v_accvgpr_write_b32 a252, v252
  v_accvgpr_write_b32 a253, v253
  v_accvgpr_write_b32 a254, v254
  v_accvgpr_write_b32 a255, v255
  s_waitcnt lgkmcnt(7)
  s_nop 0
  v_mfma_f32_16x16x32_bf16 v[100:103], a[0:3], a[84:87], 0
  v_mfma_f32_16x16x32_bf16 v[124:127], a[0:3], a[88:91], 0
  ds_read_b128 a[0:3], v50 offset:6208
  s_waitcnt lgkmcnt(7)
  s_nop 0
  v_mfma_f32_16x16x32_bf16 v[104:107], a[4:7], a[84:87], 0
  v_mfma_f32_16x16x32_bf16 v[128:131], a[4:7], a[88:91], 0
  ds_read_b128 a[4:7], v50 offset:9280
  s_waitcnt lgkmcnt(7)
  s_nop 0
  v_mfma_f32_16x16x32_bf16 v[108:111], a[8:11], a[84:87], 0
  v_mfma_f32_16x16x32_bf16 v[132:135], a[8:11], a[88:91], 0
  ds_read_b128 a[8:11], v50 offset:12352
  s_waitcnt lgkmcnt(7)
  s_nop 0
  v_mfma_f32_16x16x32_bf16 v[112:115], a[12:15], a[84:87], 0
  v_mfma_f32_16x16x32_bf16 v[136:139], a[12:15], a[88:91], 0
  ds_read_b128 a[12:15], v50 offset:15424
  s_waitcnt lgkmcnt(7)
  s_nop 0
  v_mfma_f32_16x16x32_bf16 v[116:119], a[16:19], a[84:87], 0
  v_mfma_f32_16x16x32_bf16 v[140:143], a[16:19], a[88:91], 0
  ds_read_b128 a[16:19], v50 offset:128
  s_waitcnt lgkmcnt(7)
  s_nop 0
  v_mfma_f32_16x16x32_bf16 v[120:123], a[20:23], a[84:87], 0
  v_mfma_f32_16x16x32_bf16 v[144:147], a[20:23], a[88:91], 0
  ds_read_b128 a[20:23], v50 offset:3200
  s_waitcnt lgkmcnt(7)
  s_nop 0
  v_mfma_f32_16x16x32_bf16 v[148:151], a[24:27], a[84:87], 0
  v_mfma_f32_16x16x32_bf16 v[172:175], a[24:27], a[88:91], 0
  ds_read_b128 a[24:27], v50 offset:6272
  s_waitcnt lgkmcnt(7)
  s_nop 0
  v_mfma_f32_16x16x32_bf16 v[152:155], a[28:31], a[84:87], 0
  v_mfma_f32_16x16x32_bf16 v[176:179], a[28:31], a[88:91], 0
  ds_read_b128 a[28:31], v50 offset:9344
  s_waitcnt lgkmcnt(7)
  s_nop 0
  v_mfma_f32_16x16x32_bf16 v[156:159], a[0:3], a[84:87], 0
  v_mfma_f32_16x16x32_bf16 v[180:183], a[0:3], a[88:91], 0
  ds_read_b128 a[0:3], v50 offset:12416
  s_waitcnt lgkmcnt(7)
  s_nop 0
  v_mfma_f32_16x16x32_bf16 v[160:163], a[4:7], a[84:87], 0
  v_mfma_f32_16x16x32_bf16 v[184:187], a[4:7], a[88:91], 0
  ds_read_b128 a[4:7], v50 offset:15488
  s_waitcnt lgkmcnt(7)
  v_mfma_f32_16x16x32_bf16 v[164:167], a[8:11], a[84:87], 0
  v_mfma_f32_16x16x32_bf16 v[188:191], a[8:11], a[88:91], 0
  s_waitcnt lgkmcnt(6)
  v_mfma_f32_16x16x32_bf16 v[168:171], a[12:15], a[84:87], 0
  v_mfma_f32_16x16x32_bf16 v[192:195], a[12:15], a[88:91], 0
  s_waitcnt lgkmcnt(5)
  v_mfma_f32_16x16x32_bf16 v[196:199], a[16:19], a[84:87], 0
  v_mfma_f32_16x16x32_bf16 v[220:223], a[16:19], a[88:91], 0
  s_waitcnt lgkmcnt(4)
  v_mfma_f32_16x16x32_bf16 v[200:203], a[20:23], a[84:87], 0
  v_mfma_f32_16x16x32_bf16 v[224:227], a[20:23], a[88:91], 0
  s_waitcnt lgkmcnt(3)
  v_mfma_f32_16x16x32_bf16 v[204:207], a[24:27], a[84:87], 0
  v_mfma_f32_16x16x32_bf16 v[228:231], a[24:27], a[88:91], 0
  s_waitcnt lgkmcnt(2)
  v_mfma_f32_16x16x32_bf16 v[208:211], a[28:31], a[84:87], 0
  v_mfma_f32_16x16x32_bf16 v[232:235], a[28:31], a[88:91], 0
  s_waitcnt lgkmcnt(1)
  v_mfma_f32_16x16x32_bf16 v[212:215], a[0:3], a[84:87], 0
  v_mfma_f32_16x16x32_bf16 v[236:239], a[0:3], a[88:91], 0
  s_waitcnt lgkmcnt(0)
  v_mfma_f32_16x16x32_bf16 v[216:219], a[4:7], a[84:87], 0
  v_mfma_f32_16x16x32_bf16 v[240:243], a[4:7], a[88:91], 0
  s_cmp_lg_u32 s44, 3
  s_cbranch_scc1 L_nored
  s_cmp_ge_u32 s2, 128
  s_cbranch_scc1 L_nored
  s_lshl_b32 s66, s2, 12
  s_add_u32 s66, s66, 4096
  v_add_u32 v58, s66, v1
  s_mov_b32 s68, 0
L_poll1:
  global_load_dwordx4 v[32:35], v58, s[20:21] offset:0 sc1
  global_load_dwordx4 v[36:39], v58, s[20:21] offset:1024 sc1
  global_load_dwordx4 v[40:43], v58, s[20:21] offset:2048 sc1
  global_load_dwordx4 v[44:47], v58, s[20:21] offset:3072 sc1
  s_add_u32 s68, s68, 1
  s_waitcnt vmcnt(0)
  v_cmp_eq_u32_e64 vcc, s47, v35
  v_cmp_eq_u32 s[70:71], s47, v39
  v_cmp_eq_u32 s[72:73], s47, v43
  v_cmp_eq_u32 s[74:75], s47, v47
  s_and_b64 vcc, vcc, s[70:71]
  s_nop 0
  s_and_b64 s[72:73], s[72:73], s[74:75]
  s_and_b64 vcc, vcc, s[72:73]
  s_cmp_eq_u64 vcc, exec
  s_cbranch_scc1 L_red_go
  s_cmp_lt_u32 s68, 200000
  s_cbranch_scc1 L_poll1
L_red_go:
  v_add_f32 v32, v32, v36
  v_add_f32 v40, v40, v44
  v_add_f32 v33, v33, v37
  v_add_f32 v41, v41, v45
  v_add_f32 v34, v34, v38
  v_add_f32 v42, v42, v46
  v_add_f32 v32, v32, v40
  v_add_f32 v33, v33, v41
  v_add_f32 v34, v34, v42
  v_add_f32_dpp v32, v32, v32 row_shr:1 row_mask:0xf bank_mask:0xf
  v_add_f32_dpp v33, v33, v33 row_shr:1 row_mask:0xf bank_mask:0xf
  v_add_f32_dpp v34, v34, v34 row_shr:1 row_mask:0xf bank_mask:0xf
  v_add_f32_dpp v32, v32, v32 row_shr:2 row_mask:0xf bank_mask:0xf
  v_add_f32_dpp v33, v33, v33 row_shr:2 row_mask:0xf bank_mask:0xf
  v_add_f32_dpp v34, v34, v34 row_shr:2 row_mask:0xf bank_mask:0xf
  v_add_f32_dpp v32, v32, v32 row_shr:4 row_mask:0xf bank_mask:0xf
  v_add_f32_dpp v33, v33, v33 row_shr:4 row_mask:0xf bank_mask:0xf
  v_add_f32_dpp v34, v34, v34 row_shr:4 row_mask:0xf bank_mask:0xf
  v_add_f32_dpp v32, v32, v32 row_shr:8 row_mask:0xf bank_mask:0xf
  v_add_f32_dpp v33, v33, v33 row_shr:8 row_mask:0xf bank_mask:0xf
  v_add_f32_dpp v34, v34, v34 row_shr:8 row_mask:0xf bank_mask:0xf
  v_add_f32_dpp v32, v32, v32 row_bcast:15 row_mask:0xa bank_mask:0xf
  v_add_f32_dpp v33, v33, v33 row_bcast:15 row_mask:0xa bank_mask:0xf
  v_add_f32_dpp v34, v34, v34 row_bcast:15 row_mask:0xa bank_mask:0xf
  v_add_f32_dpp v32, v32, v32 row_bcast:31 row_mask:0xc bank_mask:0xf
  v_add_f32_dpp v33, v33, v33 row_bcast:31 row_mask:0xc bank_mask:0xf
  v_add_f32_dpp v34, v34, v34 row_bcast:31 row_mask:0xc bank_mask:0xf
  v_readlane_b32 s70, v32, 63
  v_readlane_b32 s71, v33, 63
  v_readlane_b32 s72, v34, 63
  s_lshl_b32 s66, s2, 4
  s_add_u32 s66, s66, 528384
  v_lshlrev_b32 v58, 7, v1
  v_add_u32 v58, s66, v58
  v_mov_b32 v32, s70
  v_mov_b32 v33, s71
  v_mov_b32 v34, s72
  v_mov_b32_e64 v35, s47
  s_mov_b32 exec_lo, 0xffff
  s_mov_b32 exec_hi, 0
  global_store_dwordx4 v58, v[32:35], s[20:21] sc1
  s_mov_b64 exec, -1
L_nored:
  v_cvt_pk_bf16_f32 v244, v100, v101
  v_cvt_pk_bf16_f32 v245, v102, v103
  v_cvt_pk_bf16_f32 v246, v104, v105
  v_cvt_pk_bf16_f32 v247, v106, v107
  v_cvt_pk_bf16_f32 v248, v124, v125
  v_cvt_pk_bf16_f32 v249, v126, v127
  v_mfma_f32_16x16x32_bf16 v[8:11], v[244:247], a[72:75], 0
  v_cvt_pk_bf16_f32 v250, v128, v129
  v_cvt_pk_bf16_f32 v251, v130, v131
  v_cvt_pk_bf16_f32 v244, v148, v149
  v_cvt_pk_bf16_f32 v245, v150, v151
  v_mfma_f32_16x16x32_bf16 v[12:15], v[248:251], a[72:75], 0
  v_cvt_pk_bf16_f32 v246, v152, v153
  v_cvt_pk_bf16_f32 v247, v154, v155
  v_cvt_pk_bf16_f32 v248, v172, v173
  v_cvt_pk_bf16_f32 v249, v174, v175
  v_mfma_f32_16x16x32_bf16 v[16:19], v[244:247], a[72:75], 0
  v_cvt_pk_bf16_f32 v250, v176, v177
  v_cvt_pk_bf16_f32 v251, v178, v179
  v_cvt_pk_bf16_f32 v244, v196, v197
  v_cvt_pk_bf16_f32 v245, v198, v199
  v_mfma_f32_16x16x32_bf16 v[20:23], v[248:251], a[72:75], 0
  v_cvt_pk_bf16_f32 v246, v200, v201
  v_cvt_pk_bf16_f32 v247, v202, v203
  v_cvt_pk_bf16_f32 v248, v220, v221
  v_cvt_pk_bf16_f32 v249, v222, v223
  v_mfma_f32_16x16x32_bf16 v[24:27], v[244:247], a[72:75], 0
  v_cvt_pk_bf16_f32 v250, v224, v225
  v_cvt_pk_bf16_f32 v251, v226, v227
  v_cvt_pk_bf16_f32 v244, v108, v109
  v_cvt_pk_bf16_f32 v245, v110, v111
  v_mfma_f32_16x16x32_bf16 v[28:31], v[248:251], a[72:75], 0
  v_cvt_pk_bf16_f32 v246, v112, v113
  v_cvt_pk_bf16_f32 v247, v114, v115
  v_cvt_pk_bf16_f32 v248, v132, v133
  v_cvt_pk_bf16_f32 v249, v134, v135
  v_mfma_f32_16x16x32_bf16 v[8:11], v[244:247], a[76:79], v[8:11]
  v_cvt_pk_bf16_f32 v250, v136, v137
  v_cvt_pk_bf16_f32 v251, v138, v139
  v_cvt_pk_bf16_f32 v244, v156, v157
  v_cvt_pk_bf16_f32 v245, v158, v159
  v_mfma_f32_16x16x32_bf16 v[12:15], v[248:251], a[76:79], v[12:15]
  v_cvt_pk_bf16_f32 v246, v160, v161
  v_cvt_pk_bf16_f32 v247, v162, v163
  v_cvt_pk_bf16_f32 v248, v180, v181
  v_cvt_pk_bf16_f32 v249, v182, v183
  v_mfma_f32_16x16x32_bf16 v[16:19], v[244:247], a[76:79], v[16:19]
  v_cvt_pk_bf16_f32 v250, v184, v185
  v_cvt_pk_bf16_f32 v251, v186, v187
  v_cvt_pk_bf16_f32 v244, v204, v205
  v_cvt_pk_bf16_f32 v245, v206, v207
  v_mfma_f32_16x16x32_bf16 v[20:23], v[248:251], a[76:79], v[20:23]
  v_cvt_pk_bf16_f32 v246, v208, v209
  v_cvt_pk_bf16_f32 v247, v210, v211
  v_cvt_pk_bf16_f32 v248, v228, v229
  v_cvt_pk_bf16_f32 v249, v230, v231
  v_mfma_f32_16x16x32_bf16 v[24:27], v[244:247], a[76:79], v[24:27]
  v_cvt_pk_bf16_f32 v250, v232, v233
  v_cvt_pk_bf16_f32 v251, v234, v235
  v_cvt_pk_bf16_f32 v244, v116, v117
  v_cvt_pk_bf16_f32 v245, v118, v119
  v_mfma_f32_16x16x32_bf16 v[28:31], v[248:251], a[76:79], v[28:31]
  v_cvt_pk_bf16_f32 v246, v120, v121
  v_cvt_pk_bf16_f32 v247, v122, v123
  v_cvt_pk_bf16_f32 v248, v140, v141
  v_cvt_pk_bf16_f32 v249, v142, v143
  v_mfma_f32_16x16x32_bf16 v[8:11], v[244:247], a[80:83], v[8:11]
  v_cvt_pk_bf16_f32 v250, v144, v145
  v_cvt_pk_bf16_f32 v251, v146, v147
  v_cvt_pk_bf16_f32 v244, v164, v165
  v_cvt_pk_bf16_f32 v245, v166, v167
  v_mfma_f32_16x16x32_bf16 v[12:15], v[248:251], a[80:83], v[12:15]
  v_cvt_pk_bf16_f32 v246, v168, v169
  v_cvt_pk_bf16_f32 v247, v170, v171
  v_cvt_pk_bf16_f32 v248, v188, v189
  v_cvt_pk_bf16_f32 v249, v190, v191
  v_mfma_f32_16x16x32_bf16 v[16:19], v[244:247], a[80:83], v[16:19]
  v_cvt_pk_bf16_f32 v250, v192, v193
  v_cvt_pk_bf16_f32 v251, v194, v195
  v_cvt_pk_bf16_f32 v244, v212, v213
  v_cvt_pk_bf16_f32 v245, v214, v215
  v_mfma_f32_16x16x32_bf16 v[20:23], v[248:251], a[80:83], v[20:23]
  v_cvt_pk_bf16_f32 v246, v216, v217
  v_cvt_pk_bf16_f32 v247, v218, v219
  v_cvt_pk_bf16_f32 v248, v236, v237
  v_cvt_pk_bf16_f32 v249, v238, v239
  v_mfma_f32_16x16x32_bf16 v[24:27], v[244:247], a[80:83], v[24:27]
  v_cvt_pk_bf16_f32 v250, v240, v241
  v_cvt_pk_bf16_f32 v251, v242, v243
  s_nop 1
  s_nop 0
  v_mfma_f32_16x16x32_bf16 v[28:31], v[248:251], a[80:83], v[28:31]
  s_mul_i32 s66, s44, 384
  s_add_u32 s66, s66, 150528
  v_lshlrev_b32_e64 v252, 5, v3
  v_add_u32 v253, 150528, v252
  v_add_u32_e64 v252, s66, v252
  s_mov_b32 exec_lo, 0x00010001
  s_mov_b32 exec_hi, 0x00010001
  s_nop 2
  s_nop 0
  ds_write_b128 v252, v[8:11] offset:0
  ds_write_b128 v252, v[12:15] offset:16
  ds_write_b128 v252, v[16:19] offset:128
  ds_write_b128 v252, v[20:23] offset:144
  ds_write_b128 v252, v[24:27] offset:256
  ds_write_b128 v252, v[28:31] offset:272
  s_mov_b64 exec, -1
  s_waitcnt lgkmcnt(0)
  s_barrier
  s_nop 0
  ds_read_b128 v[8:11], v253 offset:0
  ds_read_b128 v[32:35], v253 offset:384
  ds_read_b128 v[36:39], v253 offset:768
  ds_read_b128 v[40:43], v253 offset:1152
  ds_read_b128 v[12:15], v253 offset:16
  ds_read_b128 v[44:47], v253 offset:400
  ds_read_b128 v[48:51], v253 offset:784
  ds_read_b128 v[52:55], v253 offset:1168
  ds_read_b128 v[16:19], v253 offset:128
  ds_read_b128 v[56:59], v253 offset:512
  ds_read_b128 v[60:63], v253 offset:896
  ds_read_b128 v[64:67], v253 offset:1280
  s_waitcnt lgkmcnt(8)
  s_nop 0
  v_pk_add_f32 v[8:9], v[8:9], v[32:33]
  v_pk_add_f32 v[36:37], v[36:37], v[40:41]
  v_pk_add_f32 v[10:11], v[10:11], v[34:35]
  v_pk_add_f32 v[38:39], v[38:39], v[42:43]
  v_pk_add_f32 v[8:9], v[8:9], v[36:37]
  v_pk_add_f32 v[10:11], v[10:11], v[38:39]
  s_waitcnt lgkmcnt(4)
  s_nop 0
  v_pk_add_f32 v[12:13], v[12:13], v[44:45]
  v_pk_add_f32 v[48:49], v[48:49], v[52:53]
  v_pk_add_f32 v[14:15], v[14:15], v[46:47]
  v_pk_add_f32 v[50:51], v[50:51], v[54:55]
  v_pk_add_f32 v[12:13], v[12:13], v[48:49]
  v_pk_add_f32 v[14:15], v[14:15], v[50:51]
  s_waitcnt lgkmcnt(0)
  s_nop 0
  v_pk_add_f32 v[16:17], v[16:17], v[56:57]
  v_pk_add_f32 v[60:61], v[60:61], v[64:65]
  v_pk_add_f32 v[18:19], v[18:19], v[58:59]
  v_pk_add_f32 v[62:63], v[62:63], v[66:67]
  v_pk_add_f32 v[16:17], v[16:17], v[60:61]
  v_pk_add_f32 v[18:19], v[18:19], v[62:63]
  ds_read_b128 v[20:23], v253 offset:144
  ds_read_b128 v[32:35], v253 offset:528
  ds_read_b128 v[36:39], v253 offset:912
  ds_read_b128 v[40:43], v253 offset:1296
  ds_read_b128 v[24:27], v253 offset:256
  ds_read_b128 v[44:47], v253 offset:640
  ds_read_b128 v[48:51], v253 offset:1024
  ds_read_b128 v[52:55], v253 offset:1408
  ds_read_b128 v[28:31], v253 offset:272
  ds_read_b128 v[56:59], v253 offset:656
  ds_read_b128 v[60:63], v253 offset:1040
  ds_read_b128 v[64:67], v253 offset:1424
  s_waitcnt lgkmcnt(8)
  s_nop 0
  v_pk_add_f32 v[20:21], v[20:21], v[32:33]
  v_pk_add_f32 v[36:37], v[36:37], v[40:41]
  v_pk_add_f32 v[22:23], v[22:23], v[34:35]
  v_pk_add_f32 v[38:39], v[38:39], v[42:43]
  v_pk_add_f32 v[20:21], v[20:21], v[36:37]
  v_pk_add_f32 v[22:23], v[22:23], v[38:39]
  s_waitcnt lgkmcnt(4)
  s_nop 0
  v_pk_add_f32 v[24:25], v[24:25], v[44:45]
  v_pk_add_f32 v[48:49], v[48:49], v[52:53]
  v_pk_add_f32 v[26:27], v[26:27], v[46:47]
  v_pk_add_f32 v[50:51], v[50:51], v[54:55]
  v_pk_add_f32 v[24:25], v[24:25], v[48:49]
  v_pk_add_f32 v[26:27], v[26:27], v[50:51]
  s_waitcnt lgkmcnt(0)
  s_nop 0
  v_pk_add_f32 v[28:29], v[28:29], v[56:57]
  v_pk_add_f32 v[60:61], v[60:61], v[64:65]
  v_pk_add_f32 v[30:31], v[30:31], v[58:59]
  v_pk_add_f32 v[62:63], v[62:63], v[66:67]
  v_pk_add_f32 v[28:29], v[28:29], v[60:61]
  v_pk_add_f32 v[30:31], v[30:31], v[62:63]
  s_cmp_lg_u32 s44, 0
  s_cbranch_scc1 L_nocv
  v_add_u32 v253, 1536, v253
  s_mov_b32 exec_lo, 0x00010001
  s_mov_b32 exec_hi, 0x00010001
  ds_write_b128 v253, v[8:11] offset:0
  ds_write_b128 v253, v[12:15] offset:16
  ds_write_b128 v253, v[16:19] offset:128
  ds_write_b128 v253, v[20:23] offset:144
  ds_write_b128 v253, v[24:27] offset:256
  ds_write_b128 v253, v[28:31] offset:272
  s_mov_b64 exec, -1
  s_waitcnt lgkmcnt(0)
L_nocv:
  v_mfma_f32_16x16x32_bf16 v[32:35], a[84:87], a[44:47], v[8:11]
  v_mfma_f32_16x16x32_bf16 v[36:39], a[88:91], a[44:47], v[12:15]
  v_mfma_f32_16x16x32_bf16 v[40:43], a[84:87], a[48:51], v[16:19]
  v_mfma_f32_16x16x32_bf16 v[44:47], a[88:91], a[48:51], v[20:23]
  v_mfma_f32_16x16x32_bf16 v[48:51], a[84:87], a[52:55], v[24:27]
  v_mfma_f32_16x16x32_bf16 v[52:55], a[88:91], a[52:55], v[28:31]
  v_mfma_f32_16x16x32_bf16 v[56:59], a[84:87], a[56:59], v[8:11]
  v_mfma_f32_16x16x32_bf16 v[60:63], a[88:91], a[56:59], v[12:15]
  v_mfma_f32_16x16x32_bf16 v[64:67], a[84:87], a[60:63], v[16:19]
  v_mfma_f32_16x16x32_bf16 v[68:71], a[88:91], a[60:63], v[20:23]
  v_mfma_f32_16x16x32_bf16 v[72:75], a[84:87], a[64:67], v[24:27]
  v_mfma_f32_16x16x32_bf16 v[76:79], a[88:91], a[64:67], v[28:31]
  v_mfma_f32_16x16x32_bf16 v[8:11], a[84:87], a[32:35], v[8:11]
  v_mfma_f32_16x16x32_bf16 v[12:15], a[88:91], a[32:35], v[12:15]
  v_mfma_f32_16x16x32_bf16 v[16:19], a[84:87], a[36:39], v[16:19]
  v_mfma_f32_16x16x32_bf16 v[20:23], a[88:91], a[36:39], v[20:23]
  v_mfma_f32_16x16x32_bf16 v[24:27], a[84:87], a[40:43], v[24:27]
  v_mfma_f32_16x16x32_bf16 v[28:31], a[88:91], a[40:43], v[28:31]
  v_accvgpr_read_b32 v0, a96
  v_accvgpr_read_b32 v2, a97
  v_accvgpr_read_b32 v3, a98
  s_cmp_lg_u32 s44, 0
  s_cbranch_scc1 L_nofin
  s_and_b32 s66, s2, 15
  s_lshl_b32 s66, s66, 11
  s_add_u32 s66, s66, 528384
  v_add_u32 v86, s66, v1
  s_mov_b32 s68, 0
  v_lshlrev_b32 v80, 16, v80
  v_lshlrev_b32 v81, 16, v81
  v_lshlrev_b32 v82, 16, v82
  v_lshlrev_b32 v83, 16, v83
  v_lshlrev_b32 v84, 16, v84
  v_lshlrev_b32 v85, 16, v85
  s_mov_b32 s76, 0x4091afa4
  v_mov_b32 v87, 0x358637bd
  v_mov_b32 v90, 0x3b2aaaab
  v_mov_b32 v89, 0xc0088e99
  v_lshrrev_b32_e64 v91, 2, v1
  v_add_u32 v91, 161280, v91
L_poll2:
  global_load_dwordx4 v[244:247], v86, s[20:21] sc1
  global_load_dwordx4 v[248:251], v86, s[20:21] offset:1024 sc1
  s_add_u32 s68, s68, 1
  s_waitcnt vmcnt(0)
  v_cmp_eq_u32_e64 vcc, s47, v247
  v_cmp_eq_u32 s[70:71], s47, v251
  s_nop 1
  s_and_b64 vcc, vcc, s[70:71]
  s_cmp_eq_u64 vcc, exec
  s_cbranch_scc1 L_fin_go
  s_cmp_lt_u32 s68, 200000
  s_cbranch_scc1 L_poll2
L_fin_go:
  s_nop 0
  v_fma_f32 v244, v244, s76, v87
  v_fma_f32 v245, v245, s76, v87
  v_fma_f32 v246, v246, s76, v87
  v_fma_f32 v248, v248, s76, v87
  v_fma_f32 v249, v249, s76, v87
  v_fma_f32 v250, v250, s76, v87
  v_sqrt_f32 v244, v244
  v_sqrt_f32 v245, v245
  v_sqrt_f32 v246, v246
  v_sqrt_f32 v248, v248
  v_sqrt_f32 v249, v249
  v_sqrt_f32 v250, v250
  v_add_f32 v88, v244, v245
  v_add_f32 v247, v246, v248
  v_add_f32 v251, v249, v250
  v_add_f32 v88, v88, v247
  v_add_f32 v88, v88, v251
  v_mul_f32_e64 v80, v80, v244
  s_nop 0
  v_add_f32_dpp v88, v88, v88 row_shr:1 row_mask:0xf bank_mask:0xf
  v_mul_f32 v81, v81, v245
  s_nop 0
  v_add_f32_dpp v88, v88, v88 row_shr:2 row_mask:0xf bank_mask:0xf
  v_mul_f32 v82, v82, v246
  s_nop 0
  v_add_f32_dpp v88, v88, v88 row_shr:4 row_mask:0xf bank_mask:0xf
  v_mul_f32 v83, v83, v248
  s_nop 0
  v_add_f32_dpp v88, v88, v88 row_shr:8 row_mask:0xf bank_mask:0xf
  v_mul_f32 v84, v84, v249
  s_nop 0
  v_add_f32_dpp v88, v88, v88 row_bcast:15 row_mask:0xa bank_mask:0xf
  v_mul_f32 v85, v85, v250
  s_nop 0
  v_add_f32_dpp v88, v88, v88 row_bcast:31 row_mask:0xc bank_mask:0xf
  s_nop 0
  v_readlane_b32 s70, v88, 63
  s_nop 1
  v_fma_f32 v88, s70, v90, v87
  v_rcp_f32 v88, v88
  s_nop 0
  v_mul_f32_e64 v88, v88, v89
  v_fma_f32 v80, v80, v88, v89
  v_fma_f32 v81, v81, v88, v89
  v_fma_f32 v82, v82, v88, v89
  v_fma_f32 v83, v83, v88, v89
  v_fma_f32 v84, v84, v88, v89
  v_fma_f32 v85, v85, v88, v89
  ds_write_b32 v91, v80 offset:0
  ds_write_b32 v91, v81 offset:512
  ds_write_b32 v91, v82 offset:1024
  ds_write_b32 v91, v83 offset:256
  ds_write_b32 v91, v84 offset:768
  ds_write_b32 v91, v85 offset:1280
  s_cmp_lg_u32 s2, 0
  s_cbranch_scc1 L_noepoch
  v_mov_b32 v86, 0
  v_mov_b32_e64 v87, s47
  s_mov_b64 exec, 1
  global_store_dword v86, v87, s[20:21] sc1
  s_mov_b64 exec, -1
L_noepoch:
L_nofin:
  s_waitcnt lgkmcnt(0)
  s_barrier
  s_nop 0
  ds_read_b128 v[80:83], v6 offset:0
  ds_read_b128 v[84:87], v6 offset:64
  ds_read_b128 v[88:91], v6 offset:128
  ds_read_b128 v[244:247], v6 offset:192
  ds_read_b128 v[248:251], v6 offset:256
  ds_read_b128 v[252:255], v6 offset:320
  s_waitcnt lgkmcnt(4)
  s_nop 0
  v_pk_mul_f32 v[100:101], v[100:101], v[80:81]
  v_pk_mul_f32 v[102:103], v[102:103], v[82:83]
  v_pk_mul_f32 v[104:105], v[104:105], v[84:85]
  v_pk_mul_f32 v[106:107], v[106:107], v[86:87]
  s_waitcnt lgkmcnt(4)
  s_nop 0
  v_pk_mul_f32 v[124:125], v[124:125], v[80:81]
  v_pk_mul_f32 v[126:127], v[126:127], v[82:83]
  v_pk_mul_f32 v[128:129], v[128:129], v[84:85]
  v_pk_mul_f32 v[130:131], v[130:131], v[86:87]
  s_waitcnt lgkmcnt(2)
  s_nop 0
  v_pk_mul_f32 v[108:109], v[108:109], v[88:89]
  v_pk_mul_f32 v[110:111], v[110:111], v[90:91]
  v_pk_mul_f32 v[112:113], v[112:113], v[244:245]
  v_pk_mul_f32 v[114:115], v[114:115], v[246:247]
  s_waitcnt lgkmcnt(2)
  s_nop 0
  v_pk_mul_f32 v[132:133], v[132:133], v[88:89]
  v_pk_mul_f32 v[134:135], v[134:135], v[90:91]
  v_pk_mul_f32 v[136:137], v[136:137], v[244:245]
  v_pk_mul_f32 v[138:139], v[138:139], v[246:247]
  s_waitcnt lgkmcnt(0)
  s_nop 0
  v_pk_mul_f32 v[116:117], v[116:117], v[248:249]
  v_pk_mul_f32 v[118:119], v[118:119], v[250:251]
  v_pk_mul_f32 v[120:121], v[120:121], v[252:253]
  v_pk_mul_f32 v[122:123], v[122:123], v[254:255]
  s_waitcnt lgkmcnt(0)
  s_nop 0
  v_pk_mul_f32 v[140:141], v[140:141], v[248:249]
  v_pk_mul_f32 v[142:143], v[142:143], v[250:251]
  v_pk_mul_f32 v[144:145], v[144:145], v[252:253]
  v_pk_mul_f32 v[146:147], v[146:147], v[254:255]
  v_cvt_pk_bf16_f32 v100, v100, v101
  v_cvt_pk_bf16_f32 v101, v102, v103
  v_cvt_pk_bf16_f32 v102, v104, v105
  v_cvt_pk_bf16_f32 v103, v106, v107
  s_nop 1
  v_mfma_f32_16x16x32_bf16 v[8:11], v[100:103], a[100:103], v[8:11]
  v_mfma_f32_16x16x32_bf16 v[32:35], v[100:103], a[148:151], v[32:35]
  ds_write_b128 v99, v[100:103] offset:0
  v_cvt_pk_bf16_f32 v124, v124, v125
  v_mfma_f32_16x16x32_bf16 v[56:59], v[100:103], a[196:199], v[56:59]
  v_cvt_pk_bf16_f32 v125, v126, v127
  v_cvt_pk_bf16_f32 v126, v128, v129
  v_mfma_f32_16x16x32_bf16 a[72:75], v[100:103], a[244:247], 0
  v_cvt_pk_bf16_f32 v127, v130, v131
  s_nop 1
  v_mfma_f32_16x16x32_bf16 v[12:15], v[124:127], a[100:103], v[12:15]
  v_mfma_f32_16x16x32_bf16 v[36:39], v[124:127], a[148:151], v[36:39]
  ds_write_b128 v99, v[124:127] offset:12288
  v_cvt_pk_bf16_f32 v108, v108, v109
  v_mfma_f32_16x16x32_bf16 v[60:63], v[124:127], a[196:199], v[60:63]
  v_cvt_pk_bf16_f32 v109, v110, v111
  v_cvt_pk_bf16_f32 v110, v112, v113
  v_mfma_f32_16x16x32_bf16 a[76:79], v[124:127], a[244:247], 0
  v_cvt_pk_bf16_f32 v111, v114, v115
  s_nop 1
  v_mfma_f32_16x16x32_bf16 v[8:11], v[108:111], a[104:107], v[8:11]
  v_mfma_f32_16x16x32_bf16 v[32:35], v[108:111], a[152:155], v[32:35]
  ds_write_b128 v99, v[108:111] offset:1024
  v_cvt_pk_bf16_f32 v132, v132, v133
  v_mfma_f32_16x16x32_bf16 v[56:59], v[108:111], a[200:203], v[56:59]
  v_cvt_pk_bf16_f32 v133, v134, v135
  v_cvt_pk_bf16_f32 v134, v136, v137
  v_mfma_f32_16x16x32_bf16 a[72:75], v[108:111], a[248:251], a[72:75]
  v_cvt_pk_bf16_f32 v135, v138, v139
  s_nop 1
  v_mfma_f32_16x16x32_bf16 v[12:15], v[132:135], a[104:107], v[12:15]
  v_mfma_f32_16x16x32_bf16 v[36:39], v[132:135], a[152:155], v[36:39]
  ds_write_b128 v99, v[132:135] offset:13312
  v_cvt_pk_bf16_f32 v116, v116, v117
  v_mfma_f32_16x16x32_bf16 v[60:63], v[132:135], a[200:203], v[60:63]
  v_cvt_pk_bf16_f32 v117, v118, v119
  v_cvt_pk_bf16_f32 v118, v120, v121
  v_mfma_f32_16x16x32_bf16 a[76:79], v[132:135], a[248:251], a[76:79]
  v_cvt_pk_bf16_f32 v119, v122, v123
  ds_write_b128 v99, v[116:119] offset:2048
  v_cvt_pk_bf16_f32 v140, v140, v141
  v_cvt_pk_bf16_f32 v141, v142, v143
  v_cvt_pk_bf16_f32 v142, v144, v145
  v_cvt_pk_bf16_f32 v143, v146, v147
  ds_write_b128 v99, v[140:143] offset:14336
  s_waitcnt lgkmcnt(0)
  s_barrier
  v_mfma_f32_16x16x32_bf16 v[8:11], v[116:119], a[108:111], v[8:11]
  ds_read_b128 a[0:3], v96 offset:0
  v_mul_f32_e64 v148, v148, v80
  v_mfma_f32_16x16x32_bf16 v[32:35], v[116:119], a[156:159], v[32:35]
  ds_read_b128 a[4:7], v96 offset:12288
  v_mul_f32_e64 v149, v149, v81
  v_mfma_f32_16x16x32_bf16 v[56:59], v[116:119], a[204:207], v[56:59]
  ds_read_b128 a[8:11], v96 offset:1024
  v_mul_f32_e64 v150, v150, v82
  v_mfma_f32_16x16x32_bf16 a[72:75], v[116:119], a[252:255], a[72:75]
  v_mul_f32 v151, v151, v83
  v_mul_f32 v152, v152, v84
  v_mfma_f32_16x16x32_bf16 v[12:15], v[140:143], a[108:111], v[12:15]
  ds_read_b128 a[12:15], v96 offset:13312
  v_mul_f32_e64 v153, v153, v85
  v_mfma_f32_16x16x32_bf16 v[36:39], v[140:143], a[156:159], v[36:39]
  ds_read_b128 a[16:19], v96 offset:2048
  v_mul_f32_e64 v154, v154, v86
  v_mfma_f32_16x16x32_bf16 v[60:63], v[140:143], a[204:207], v[60:63]
  ds_read_b128 a[20:23], v96 offset:14336
  v_mul_f32_e64 v155, v155, v87
  v_mfma_f32_16x16x32_bf16 a[76:79], v[140:143], a[252:255], a[76:79]
  v_cvt_pk_bf16_f32 v148, v148, v149
  v_cvt_pk_bf16_f32 v149, v150, v151
  s_waitcnt lgkmcnt(5)
  v_mfma_f32_16x16x32_bf16 v[8:11], a[0:3], a[112:115], v[8:11]
  ds_read_b128 a[24:27], v97 offset:0
  s_waitcnt lgkmcnt(5)
  v_mfma_f32_16x16x32_bf16 v[12:15], a[4:7], a[112:115], v[12:15]
  ds_read_b128 a[28:31], v97 offset:12288
  s_waitcnt lgkmcnt(5)
  v_mfma_f32_16x16x32_bf16 v[8:11], a[8:11], a[116:119], v[8:11]
  ds_read_b128 a[32:35], v97 offset:1024
  s_waitcnt lgkmcnt(5)
  v_mfma_f32_16x16x32_bf16 v[12:15], a[12:15], a[116:119], v[12:15]
  ds_read_b128 a[36:39], v97 offset:13312
  s_waitcnt lgkmcnt(5)
  v_mfma_f32_16x16x32_bf16 v[8:11], a[16:19], a[120:123], v[8:11]
  ds_read_b128 a[40:43], v97 offset:2048
  s_waitcnt lgkmcnt(5)
  v_mfma_f32_16x16x32_bf16 v[12:15], a[20:23], a[120:123], v[12:15]
  ds_read_b128 a[44:47], v97 offset:14336
  s_waitcnt lgkmcnt(5)
  v_mfma_f32_16x16x32_bf16 v[8:11], a[24:27], a[124:127], v[8:11]
  ds_read_b128 a[48:51], v98 offset:0
  s_waitcnt lgkmcnt(5)
  v_mfma_f32_16x16x32_bf16 v[12:15], a[28:31], a[124:127], v[12:15]
  ds_read_b128 a[52:55], v98 offset:12288
  s_waitcnt lgkmcnt(5)
  v_mfma_f32_16x16x32_bf16 v[8:11], a[32:35], a[128:131], v[8:11]
  ds_read_b128 a[56:59], v98 offset:1024
  s_waitcnt lgkmcnt(5)
  v_mfma_f32_16x16x32_bf16 v[12:15], a[36:39], a[128:131], v[12:15]
  ds_read_b128 a[60:63], v98 offset:13312
  s_waitcnt lgkmcnt(5)
  v_mfma_f32_16x16x32_bf16 v[8:11], a[40:43], a[132:135], v[8:11]
  ds_read_b128 a[64:67], v98 offset:2048
  s_waitcnt lgkmcnt(5)
  v_mfma_f32_16x16x32_bf16 v[12:15], a[44:47], a[132:135], v[12:15]
  ds_read_b128 a[68:71], v98 offset:14336
  s_waitcnt lgkmcnt(5)
  v_mfma_f32_16x16x32_bf16 v[8:11], a[48:51], a[136:139], v[8:11]
  s_mov_b32 exec_lo, 0x000f000f
  s_mov_b32 exec_hi, 0x000f000f
  ds_write_b128 v5, a[72:75] offset:0
  ds_write_b128 v5, a[76:79] offset:16
  s_mov_b64 exec, -1
  s_waitcnt lgkmcnt(6)
  v_mfma_f32_16x16x32_bf16 v[12:15], a[52:55], a[136:139], v[12:15]
  v_cvt_pk_bf16_f32 v150, v152, v153
  s_waitcnt lgkmcnt(5)
  v_mfma_f32_16x16x32_bf16 v[8:11], a[56:59], a[140:143], v[8:11]
  v_cvt_pk_bf16_f32 v151, v154, v155
  s_waitcnt lgkmcnt(4)
  v_mfma_f32_16x16x32_bf16 v[12:15], a[60:63], a[140:143], v[12:15]
  ds_write_b128 v99, v[148:151] offset:24576
  s_waitcnt lgkmcnt(4)
  v_mfma_f32_16x16x32_bf16 v[8:11], a[64:67], a[144:147], v[8:11]
  v_mul_f32 v172, v172, v80
  s_waitcnt lgkmcnt(3)
  v_mfma_f32_16x16x32_bf16 v[12:15], a[68:71], a[144:147], v[12:15]
  v_mul_f32_e64 v173, v173, v81
  v_mfma_f32_16x16x32_bf16 v[32:35], a[0:3], a[160:163], v[32:35]
  v_mul_f32 v174, v174, v82
  v_mul_f32 v175, v175, v83
  v_mfma_f32_16x16x32_bf16 v[36:39], a[4:7], a[160:163], v[36:39]
  v_mul_f32 v176, v176, v84
  v_mul_f32 v177, v177, v85
  v_mfma_f32_16x16x32_bf16 v[32:35], a[8:11], a[164:167], v[32:35]
  v_cvt_pk_bf16_f32 v104, v8, v9
  v_cvt_pk_bf16_f32 v105, v10, v11
  v_mfma_f32_16x16x32_bf16 v[36:39], a[12:15], a[164:167], v[36:39]
  v_cvt_pk_bf16_f32 v106, v12, v13
  v_cvt_pk_bf16_f32 v107, v14, v15
  v_mfma_f32_16x16x32_bf16 v[32:35], a[16:19], a[168:171], v[32:35]
  buffer_store_dwordx4 v[104:107], v0, s[40:43], 0 offen offset:0 sc1
  v_mul_f32_e64 v178, v178, v86
  v_mfma_f32_16x16x32_bf16 v[36:39], a[20:23], a[168:171], v[36:39]
  v_mul_f32_e64 v179, v179, v87
  v_cvt_pk_bf16_f32 v172, v172, v173
  v_mfma_f32_16x16x32_bf16 v[32:35], a[24:27], a[172:175], v[32:35]
  v_cvt_pk_bf16_f32 v173, v174, v175
  v_cvt_pk_bf16_f32 v174, v176, v177
  v_mfma_f32_16x16x32_bf16 v[36:39], a[28:31], a[172:175], v[36:39]
  v_cvt_pk_bf16_f32 v175, v178, v179
  v_mfma_f32_16x16x32_bf16 v[32:35], a[32:35], a[176:179], v[32:35]
  v_mfma_f32_16x16x32_bf16 v[36:39], a[36:39], a[176:179], v[36:39]
  ds_write_b128 v99, v[172:175] offset:36864
  v_mul_f32_e64 v156, v156, v88
  v_mfma_f32_16x16x32_bf16 v[32:35], a[40:43], a[180:183], v[32:35]
  v_mul_f32 v157, v157, v89
  v_mul_f32 v158, v158, v90
  v_mfma_f32_16x16x32_bf16 v[36:39], a[44:47], a[180:183], v[36:39]
  v_mul_f32 v159, v159, v91
  v_mul_f32 v160, v160, v244
  v_mfma_f32_16x16x32_bf16 v[32:35], a[48:51], a[184:187], v[32:35]
  v_mul_f32 v161, v161, v245
  v_mul_f32 v162, v162, v246
  v_mfma_f32_16x16x32_bf16 v[36:39], a[52:55], a[184:187], v[36:39]
  v_mul_f32_e64 v163, v163, v247
  v_cvt_pk_bf16_f32 v156, v156, v157
  v_mfma_f32_16x16x32_bf16 v[32:35], a[56:59], a[188:191], v[32:35]
  v_cvt_pk_bf16_f32 v157, v158, v159
  v_cvt_pk_bf16_f32 v158, v160, v161
  v_mfma_f32_16x16x32_bf16 v[36:39], a[60:63], a[188:191], v[36:39]
  v_cvt_pk_bf16_f32 v159, v162, v163
  v_mfma_f32_16x16x32_bf16 v[32:35], a[64:67], a[192:195], v[32:35]
  v_mfma_f32_16x16x32_bf16 v[36:39], a[68:71], a[192:195], v[36:39]
  v_mfma_f32_16x16x32_bf16 v[56:59], a[0:3], a[208:211], v[56:59]
  ds_write_b128 v99, v[156:159] offset:25600
  v_mul_f32_e64 v180, v180, v88
  v_mfma_f32_16x16x32_bf16 v[60:63], a[4:7], a[208:211], v[60:63]
  v_mul_f32 v181, v181, v89
  v_mul_f32 v182, v182, v90
  v_mfma_f32_16x16x32_bf16 v[56:59], a[8:11], a[212:215], v[56:59]
  v_cvt_pk_bf16_f32 v112, v32, v33
  v_cvt_pk_bf16_f32 v113, v34, v35
  v_mfma_f32_16x16x32_bf16 v[60:63], a[12:15], a[212:215], v[60:63]
  v_cvt_pk_bf16_f32 v114, v36, v37
  v_cvt_pk_bf16_f32 v115, v38, v39
  v_mfma_f32_16x16x32_bf16 v[56:59], a[16:19], a[216:219], v[56:59]
  buffer_store_dwordx4 v[112:115], v2, s[40:43], 0 offen offset:0 sc1
  v_mul_f32_e64 v183, v183, v91
  v_mfma_f32_16x16x32_bf16 v[60:63], a[20:23], a[216:219], v[60:63]
  v_mul_f32 v184, v184, v244
  v_mul_f32 v185, v185, v245
  v_mfma_f32_16x16x32_bf16 v[56:59], a[24:27], a[220:223], v[56:59]
  v_mul_f32 v186, v186, v246
  v_mul_f32 v187, v187, v247
  v_mfma_f32_16x16x32_bf16 v[60:63], a[28:31], a[220:223], v[60:63]
  v_cvt_pk_bf16_f32 v180, v180, v181
  v_cvt_pk_bf16_f32 v181, v182, v183
  v_mfma_f32_16x16x32_bf16 v[56:59], a[32:35], a[224:227], v[56:59]
  v_cvt_pk_bf16_f32 v182, v184, v185
  v_cvt_pk_bf16_f32 v183, v186, v187
  v_mfma_f32_16x16x32_bf16 v[60:63], a[36:39], a[224:227], v[60:63]
  ds_write_b128 v99, v[180:183] offset:37888
  v_mul_f32_e64 v164, v164, v248
  v_mfma_f32_16x16x32_bf16 v[56:59], a[40:43], a[228:231], v[56:59]
  v_mul_f32 v165, v165, v249
  v_mul_f32 v166, v166, v250
  v_mfma_f32_16x16x32_bf16 v[60:63], a[44:47], a[228:231], v[60:63]
  v_mul_f32 v167, v167, v251
  v_mul_f32 v168, v168, v252
  v_mfma_f32_16x16x32_bf16 v[56:59], a[48:51], a[232:235], v[56:59]
  v_mul_f32 v169, v169, v253
  v_mul_f32 v170, v170, v254
  v_mfma_f32_16x16x32_bf16 v[60:63], a[52:55], a[232:235], v[60:63]
  v_mul_f32_e64 v171, v171, v255
  v_cvt_pk_bf16_f32 v164, v164, v165
  v_mfma_f32_16x16x32_bf16 v[56:59], a[56:59], a[236:239], v[56:59]
  v_cvt_pk_bf16_f32 v165, v166, v167
  v_cvt_pk_bf16_f32 v166, v168, v169
  v_mfma_f32_16x16x32_bf16 v[60:63], a[60:63], a[236:239], v[60:63]
  v_cvt_pk_bf16_f32 v167, v170, v171
  v_mfma_f32_16x16x32_bf16 v[56:59], a[64:67], a[240:243], v[56:59]
  v_mfma_f32_16x16x32_bf16 v[60:63], a[68:71], a[240:243], v[60:63]
  ds_write_b128 v99, v[164:167] offset:26624
  v_mul_f32 v188, v188, v248
  v_mul_f32 v189, v189, v249
  v_mul_f32 v190, v190, v250
  v_mul_f32 v191, v191, v251
  v_mul_f32 v192, v192, v252
  v_mul_f32 v193, v193, v253
  v_mul_f32 v194, v194, v254
  v_mul_f32 v195, v195, v255
  v_cvt_pk_bf16_f32 v188, v188, v189
  v_cvt_pk_bf16_f32 v189, v190, v191
  v_cvt_pk_bf16_f32 v190, v192, v193
  v_cvt_pk_bf16_f32 v191, v194, v195
  v_mfma_f32_16x16x32_bf16 v[16:19], v[148:151], a[100:103], v[16:19]
  v_mfma_f32_16x16x32_bf16 v[40:43], v[148:151], a[148:151], v[40:43]
  v_mfma_f32_16x16x32_bf16 v[64:67], v[148:151], a[196:199], v[64:67]
  v_cvt_pk_bf16_f32 v104, v56, v57
  v_mfma_f32_16x16x32_bf16 a[72:75], v[148:151], a[244:247], 0
  v_cvt_pk_bf16_f32 v105, v58, v59
  v_cvt_pk_bf16_f32 v106, v60, v61
  v_mfma_f32_16x16x32_bf16 v[20:23], v[172:175], a[100:103], v[20:23]
  v_cvt_pk_bf16_f32 v107, v62, v63
  buffer_store_dwordx4 v[104:107], v3, s[40:43], 0 offen offset:0 sc1
  v_mfma_f32_16x16x32_bf16 v[44:47], v[172:175], a[148:151], v[44:47]
  ds_write_b128 v99, v[188:191] offset:38912
  v_mfma_f32_16x16x32_bf16 v[68:71], v[172:175], a[196:199], v[68:71]
  v_mfma_f32_16x16x32_bf16 a[76:79], v[172:175], a[244:247], 0
  v_mfma_f32_16x16x32_bf16 v[16:19], v[156:159], a[104:107], v[16:19]
  v_mfma_f32_16x16x32_bf16 v[40:43], v[156:159], a[152:155], v[40:43]
  v_mfma_f32_16x16x32_bf16 v[64:67], v[156:159], a[200:203], v[64:67]
  v_mfma_f32_16x16x32_bf16 a[72:75], v[156:159], a[248:251], a[72:75]
  s_waitcnt lgkmcnt(0)
  s_barrier
  v_mfma_f32_16x16x32_bf16 v[20:23], v[180:183], a[104:107], v[20:23]
  ds_read_b128 a[0:3], v96 offset:24576
  v_mul_f32_e64 v196, v196, v80
  v_mfma_f32_16x16x32_bf16 v[44:47], v[180:183], a[152:155], v[44:47]
  ds_read_b128 a[4:7], v96 offset:36864
  v_mul_f32_e64 v197, v197, v81
  v_mfma_f32_16x16x32_bf16 v[68:71], v[180:183], a[200:203], v[68:71]
  ds_read_b128 a[8:11], v96 offset:25600
  v_mul_f32_e64 v198, v198, v82
  v_mfma_f32_16x16x32_bf16 a[76:79], v[180:183], a[248:251], a[76:79]
  v_mul_f32 v199, v199, v83
  v_mul_f32 v200, v200, v84
  v_mfma_f32_16x16x32_bf16 v[16:19], v[164:167], a[108:111], v[16:19]
  ds_read_b128 a[12:15], v96 offset:37888
  v_mul_f32_e64 v201, v201, v85
  v_mfma_f32_16x16x32_bf16 v[40:43], v[164:167], a[156:159], v[40:43]
  ds_read_b128 a[16:19], v96 offset:26624
  v_mul_f32_e64 v202, v202, v86
  v_mfma_f32_16x16x32_bf16 v[64:67], v[164:167], a[204:207], v[64:67]
  ds_read_b128 a[20:23], v96 offset:38912
  v_mul_f32_e64 v203, v203, v87
  v_mfma_f32_16x16x32_bf16 a[72:75], v[164:167], a[252:255], a[72:75]
  v_cvt_pk_bf16_f32 v196, v196, v197
  v_cvt_pk_bf16_f32 v197, v198, v199
  v_mfma_f32_16x16x32_bf16 v[20:23], v[188:191], a[108:111], v[20:23]
  ds_read_b128 a[24:27], v97 offset:24576
  v_cvt_pk_bf16_f32 v198, v200, v201
  v_mfma_f32_16x16x32_bf16 v[44:47], v[188:191], a[156:159], v[44:47]
  ds_read_b128 a[28:31], v97 offset:36864
  v_cvt_pk_bf16_f32 v199, v202, v203
  v_mfma_f32_16x16x32_bf16 v[68:71], v[188:191], a[204:207], v[68:71]
  ds_read_b128 a[32:35], v97 offset:25600
  v_mfma_f32_16x16x32_bf16 a[76:79], v[188:191], a[252:255], a[76:79]
  ds_write_b128 v99, v[196:199] offset:49152
  v_mul_f32 v220, v220, v80
  s_waitcnt lgkmcnt(9)
  v_mfma_f32_16x16x32_bf16 v[16:19], a[0:3], a[112:115], v[16:19]
  ds_read_b128 a[36:39], v97 offset:37888
  s_waitcnt lgkmcnt(9)
  v_mfma_f32_16x16x32_bf16 v[20:23], a[4:7], a[112:115], v[20:23]
  ds_read_b128 a[40:43], v97 offset:26624
  s_waitcnt lgkmcnt(9)
  v_mfma_f32_16x16x32_bf16 v[16:19], a[8:11], a[116:119], v[16:19]
  ds_read_b128 a[44:47], v97 offset:38912
  s_waitcnt lgkmcnt(9)
  v_mfma_f32_16x16x32_bf16 v[20:23], a[12:15], a[116:119], v[20:23]
  ds_read_b128 a[48:51], v98 offset:24576
  s_waitcnt lgkmcnt(9)
  v_mfma_f32_16x16x32_bf16 v[16:19], a[16:19], a[120:123], v[16:19]
  ds_read_b128 a[52:55], v98 offset:36864
  s_waitcnt lgkmcnt(9)
  v_mfma_f32_16x16x32_bf16 v[20:23], a[20:23], a[120:123], v[20:23]
  ds_read_b128 a[56:59], v98 offset:25600
  s_waitcnt lgkmcnt(9)
  v_mfma_f32_16x16x32_bf16 v[16:19], a[24:27], a[124:127], v[16:19]
  ds_read_b128 a[60:63], v98 offset:37888
  s_waitcnt lgkmcnt(9)
  v_mfma_f32_16x16x32_bf16 v[20:23], a[28:31], a[124:127], v[20:23]
  ds_read_b128 a[64:67], v98 offset:26624
  s_waitcnt lgkmcnt(9)
  v_mfma_f32_16x16x32_bf16 v[16:19], a[32:35], a[128:131], v[16:19]
  ds_read_b128 a[68:71], v98 offset:38912
  s_waitcnt lgkmcnt(8)
  v_mfma_f32_16x16x32_bf16 v[20:23], a[36:39], a[128:131], v[20:23]
  s_mov_b32 exec_lo, 0x000f000f
  s_mov_b32 exec_hi, 0x000f000f
  ds_write_b128 v5, a[72:75] offset:128
  ds_write_b128 v5, a[76:79] offset:144
  s_mov_b64 exec, -1
  s_waitcnt lgkmcnt(9)
  v_mfma_f32_16x16x32_bf16 v[16:19], a[40:43], a[132:135], v[16:19]
  v_mul_f32_e64 v221, v221, v81
  s_waitcnt lgkmcnt(8)
  v_mfma_f32_16x16x32_bf16 v[20:23], a[44:47], a[132:135], v[20:23]
  v_mul_f32 v222, v222, v82
  s_waitcnt lgkmcnt(7)
  v_mfma_f32_16x16x32_bf16 v[16:19], a[48:51], a[136:139], v[16:19]
  v_mul_f32 v223, v223, v83
  s_waitcnt lgkmcnt(6)
  v_mfma_f32_16x16x32_bf16 v[20:23], a[52:55], a[136:139], v[20:23]
  v_mul_f32 v224, v224, v84
  s_waitcnt lgkmcnt(5)
  v_mfma_f32_16x16x32_bf16 v[16:19], a[56:59], a[140:143], v[16:19]
  v_mul_f32 v225, v225, v85
  s_waitcnt lgkmcnt(4)
  v_mfma_f32_16x16x32_bf16 v[20:23], a[60:63], a[140:143], v[20:23]
  v_mul_f32 v226, v226, v86
  s_waitcnt lgkmcnt(3)
  v_mfma_f32_16x16x32_bf16 v[16:19], a[64:67], a[144:147], v[16:19]
  v_mul_f32 v227, v227, v87
  s_waitcnt lgkmcnt(2)
  v_mfma_f32_16x16x32_bf16 v[20:23], a[68:71], a[144:147], v[20:23]
  v_cvt_pk_bf16_f32 v220, v220, v221
  v_mfma_f32_16x16x32_bf16 v[40:43], a[0:3], a[160:163], v[40:43]
  v_cvt_pk_bf16_f32 v221, v222, v223
  v_cvt_pk_bf16_f32 v222, v224, v225
  v_mfma_f32_16x16x32_bf16 v[44:47], a[4:7], a[160:163], v[44:47]
  v_cvt_pk_bf16_f32 v223, v226, v227
  v_mfma_f32_16x16x32_bf16 v[40:43], a[8:11], a[164:167], v[40:43]
  v_cvt_pk_bf16_f32 v104, v16, v17
  v_cvt_pk_bf16_f32 v105, v18, v19
  v_mfma_f32_16x16x32_bf16 v[44:47], a[12:15], a[164:167], v[44:47]
  v_cvt_pk_bf16_f32 v106, v20, v21
  v_cvt_pk_bf16_f32 v107, v22, v23
  v_mfma_f32_16x16x32_bf16 v[40:43], a[16:19], a[168:171], v[40:43]
  buffer_store_dwordx4 v[104:107], v0, s[40:43], 0 offen offset:64 sc1
  v_mfma_f32_16x16x32_bf16 v[44:47], a[20:23], a[168:171], v[44:47]
  v_mfma_f32_16x16x32_bf16 v[40:43], a[24:27], a[172:175], v[40:43]
  ds_write_b128 v99, v[220:223] offset:61440
  v_mul_f32_e64 v204, v204, v88
  v_mfma_f32_16x16x32_bf16 v[44:47], a[28:31], a[172:175], v[44:47]
  v_mul_f32 v205, v205, v89
  v_mul_f32 v206, v206, v90
  v_mfma_f32_16x16x32_bf16 v[40:43], a[32:35], a[176:179], v[40:43]
  v_mul_f32 v207, v207, v91
  v_mul_f32 v208, v208, v244
  v_mfma_f32_16x16x32_bf16 v[44:47], a[36:39], a[176:179], v[44:47]
  v_mul_f32 v209, v209, v245
  v_mul_f32 v210, v210, v246
  v_mfma_f32_16x16x32_bf16 v[40:43], a[40:43], a[180:183], v[40:43]
  v_mul_f32_e64 v211, v211, v247
  v_cvt_pk_bf16_f32 v204, v204, v205
  v_mfma_f32_16x16x32_bf16 v[44:47], a[44:47], a[180:183], v[44:47]
  v_cvt_pk_bf16_f32 v205, v206, v207
  v_cvt_pk_bf16_f32 v206, v208, v209
  v_mfma_f32_16x16x32_bf16 v[40:43], a[48:51], a[184:187], v[40:43]
  v_cvt_pk_bf16_f32 v207, v210, v211
  v_mfma_f32_16x16x32_bf16 v[44:47], a[52:55], a[184:187], v[44:47]
  v_mfma_f32_16x16x32_bf16 v[40:43], a[56:59], a[188:191], v[40:43]
  v_mfma_f32_16x16x32_bf16 v[44:47], a[60:63], a[188:191], v[44:47]
  ds_write_b128 v99, v[204:207] offset:50176
  v_mul_f32_e64 v228, v228, v88
  v_mfma_f32_16x16x32_bf16 v[40:43], a[64:67], a[192:195], v[40:43]
  v_mul_f32 v229, v229, v89
  v_mul_f32 v230, v230, v90
  v_mfma_f32_16x16x32_bf16 v[44:47], a[68:71], a[192:195], v[44:47]
  v_mul_f32 v231, v231, v91
  v_mul_f32 v232, v232, v244
  v_mfma_f32_16x16x32_bf16 v[64:67], a[0:3], a[208:211], v[64:67]
  v_mul_f32 v233, v233, v245
  v_mul_f32 v234, v234, v246
  v_mfma_f32_16x16x32_bf16 v[68:71], a[4:7], a[208:211], v[68:71]
  v_mul_f32_e64 v235, v235, v247
  v_cvt_pk_bf16_f32 v228, v228, v229
  v_mfma_f32_16x16x32_bf16 v[64:67], a[8:11], a[212:215], v[64:67]
  v_cvt_pk_bf16_f32 v112, v40, v41
  v_cvt_pk_bf16_f32 v113, v42, v43
  v_mfma_f32_16x16x32_bf16 v[68:71], a[12:15], a[212:215], v[68:71]
  v_cvt_pk_bf16_f32 v114, v44, v45
  v_cvt_pk_bf16_f32 v115, v46, v47
  v_mfma_f32_16x16x32_bf16 v[64:67], a[16:19], a[216:219], v[64:67]
  buffer_store_dwordx4 v[112:115], v2, s[40:43], 0 offen offset:64 sc1
  v_cvt_pk_bf16_f32 v229, v230, v231
  v_mfma_f32_16x16x32_bf16 v[68:71], a[20:23], a[216:219], v[68:71]
  v_cvt_pk_bf16_f32 v230, v232, v233
  v_cvt_pk_bf16_f32 v231, v234, v235
  v_mfma_f32_16x16x32_bf16 v[64:67], a[24:27], a[220:223], v[64:67]
  ds_write_b128 v99, v[228:231] offset:62464
  v_mul_f32_e64 v212, v212, v248
  v_mfma_f32_16x16x32_bf16 v[68:71], a[28:31], a[220:223], v[68:71]
  v_mul_f32 v213, v213, v249
  v_mul_f32 v214, v214, v250
  v_mfma_f32_16x16x32_bf16 v[64:67], a[32:35], a[224:227], v[64:67]
  v_mul_f32 v215, v215, v251
  v_mul_f32 v216, v216, v252
  v_mfma_f32_16x16x32_bf16 v[68:71], a[36:39], a[224:227], v[68:71]
  v_mul_f32 v217, v217, v253
  v_mul_f32 v218, v218, v254
  v_mfma_f32_16x16x32_bf16 v[64:67], a[40:43], a[228:231], v[64:67]
  v_mul_f32_e64 v219, v219, v255
  v_cvt_pk_bf16_f32 v212, v212, v213
  v_mfma_f32_16x16x32_bf16 v[68:71], a[44:47], a[228:231], v[68:71]
  v_cvt_pk_bf16_f32 v213, v214, v215
  v_cvt_pk_bf16_f32 v214, v216, v217
  v_mfma_f32_16x16x32_bf16 v[64:67], a[48:51], a[232:235], v[64:67]
  v_cvt_pk_bf16_f32 v215, v218, v219
  v_mfma_f32_16x16x32_bf16 v[68:71], a[52:55], a[232:235], v[68:71]
  v_mfma_f32_16x16x32_bf16 v[64:67], a[56:59], a[236:239], v[64:67]
  v_mfma_f32_16x16x32_bf16 v[68:71], a[60:63], a[236:239], v[68:71]
  ds_write_b128 v99, v[212:215] offset:51200
  v_mul_f32_e64 v236, v236, v248
  v_mfma_f32_16x16x32_bf16 v[64:67], a[64:67], a[240:243], v[64:67]
  v_mul_f32 v237, v237, v249
  v_mul_f32 v238, v238, v250
  v_mfma_f32_16x16x32_bf16 v[68:71], a[68:71], a[240:243], v[68:71]
  v_mul_f32 v239, v239, v251
  v_mul_f32 v240, v240, v252
  v_mul_f32 v241, v241, v253
  v_mul_f32 v242, v242, v254
  v_mul_f32_e64 v243, v243, v255
  v_cvt_pk_bf16_f32 v236, v236, v237
  v_cvt_pk_bf16_f32 v237, v238, v239
  v_cvt_pk_bf16_f32 v238, v240, v241
  v_cvt_pk_bf16_f32 v239, v242, v243
  s_nop 1
  v_mfma_f32_16x16x32_bf16 a[72:75], v[196:199], a[244:247], 0
  ds_write_b128 v99, v[236:239] offset:63488
  v_mfma_f32_16x16x32_bf16 a[76:79], v[220:223], a[244:247], 0
  v_mfma_f32_16x16x32_bf16 a[72:75], v[204:207], a[248:251], a[72:75]
  v_mfma_f32_16x16x32_bf16 a[76:79], v[228:231], a[248:251], a[76:79]
  v_mfma_f32_16x16x32_bf16 a[72:75], v[212:215], a[252:255], a[72:75]
  v_mfma_f32_16x16x32_bf16 a[76:79], v[236:239], a[252:255], a[76:79]
  v_mfma_f32_16x16x32_bf16 v[24:27], v[196:199], a[100:103], v[24:27]
  v_mfma_f32_16x16x32_bf16 v[48:51], v[196:199], a[148:151], v[48:51]
  v_mfma_f32_16x16x32_bf16 v[72:75], v[196:199], a[196:199], v[72:75]
  v_cvt_pk_bf16_f32 v104, v64, v65
  v_mfma_f32_16x16x32_bf16 v[28:31], v[220:223], a[100:103], v[28:31]
  v_mfma_f32_16x16x32_bf16 v[52:55], v[220:223], a[148:151], v[52:55]
  s_mov_b32 exec_lo, 0x000f000f
  s_mov_b32 exec_hi, 0x000f000f
  ds_write_b128 v5, a[72:75] offset:256
  ds_write_b128 v5, a[76:79] offset:272
  s_mov_b64 exec, -1
  v_cvt_pk_bf16_f32 v105, v66, v67
  v_mfma_f32_16x16x32_bf16 v[76:79], v[220:223], a[196:199], v[76:79]
  v_cvt_pk_bf16_f32 v106, v68, v69
  v_cvt_pk_bf16_f32 v107, v70, v71
  v_mfma_f32_16x16x32_bf16 v[24:27], v[204:207], a[104:107], v[24:27]
  buffer_store_dwordx4 v[104:107], v3, s[40:43], 0 offen offset:64 sc1
  v_mfma_f32_16x16x32_bf16 v[48:51], v[204:207], a[152:155], v[48:51]
  v_mfma_f32_16x16x32_bf16 v[72:75], v[204:207], a[200:203], v[72:75]
  s_waitcnt lgkmcnt(0)
  s_barrier
  v_mfma_f32_16x16x32_bf16 v[28:31], v[228:231], a[104:107], v[28:31]
  ds_read_b128 a[0:3], v96 offset:49152
  v_mfma_f32_16x16x32_bf16 v[52:55], v[228:231], a[152:155], v[52:55]
  ds_read_b128 a[4:7], v96 offset:61440
  v_mfma_f32_16x16x32_bf16 v[76:79], v[228:231], a[200:203], v[76:79]
  ds_read_b128 a[8:11], v96 offset:50176
  v_mfma_f32_16x16x32_bf16 v[24:27], v[212:215], a[108:111], v[24:27]
  ds_read_b128 a[12:15], v96 offset:62464
  v_mfma_f32_16x16x32_bf16 v[48:51], v[212:215], a[156:159], v[48:51]
  ds_read_b128 a[16:19], v96 offset:51200
  v_mfma_f32_16x16x32_bf16 v[72:75], v[212:215], a[204:207], v[72:75]
  ds_read_b128 a[20:23], v96 offset:63488
  v_mfma_f32_16x16x32_bf16 v[28:31], v[236:239], a[108:111], v[28:31]
  ds_read_b128 a[24:27], v97 offset:49152
  v_mfma_f32_16x16x32_bf16 v[52:55], v[236:239], a[156:159], v[52:55]
  ds_read_b128 a[28:31], v97 offset:61440
  v_mfma_f32_16x16x32_bf16 v[76:79], v[236:239], a[204:207], v[76:79]
  ds_read_b128 a[32:35], v97 offset:50176
  s_waitcnt lgkmcnt(8)
  v_mfma_f32_16x16x32_bf16 v[24:27], a[0:3], a[112:115], v[24:27]
  ds_read_b128 a[36:39], v97 offset:62464
  s_waitcnt lgkmcnt(8)
  v_mfma_f32_16x16x32_bf16 v[28:31], a[4:7], a[112:115], v[28:31]
  ds_read_b128 a[40:43], v97 offset:51200
  s_waitcnt lgkmcnt(8)
  v_mfma_f32_16x16x32_bf16 v[24:27], a[8:11], a[116:119], v[24:27]
  ds_read_b128 a[44:47], v97 offset:63488
  s_waitcnt lgkmcnt(8)
  v_mfma_f32_16x16x32_bf16 v[28:31], a[12:15], a[116:119], v[28:31]
  ds_read_b128 a[48:51], v98 offset:49152
  s_waitcnt lgkmcnt(8)
  v_mfma_f32_16x16x32_bf16 v[24:27], a[16:19], a[120:123], v[24:27]
  ds_read_b128 a[52:55], v98 offset:61440
  s_waitcnt lgkmcnt(8)
  v_mfma_f32_16x16x32_bf16 v[28:31], a[20:23], a[120:123], v[28:31]
  ds_read_b128 a[56:59], v98 offset:50176
  s_waitcnt lgkmcnt(8)
  v_mfma_f32_16x16x32_bf16 v[24:27], a[24:27], a[124:127], v[24:27]
  ds_read_b128 a[60:63], v98 offset:62464
  s_waitcnt lgkmcnt(8)
  v_mfma_f32_16x16x32_bf16 v[28:31], a[28:31], a[124:127], v[28:31]
  ds_read_b128 a[64:67], v98 offset:51200
  s_waitcnt lgkmcnt(8)
  v_mfma_f32_16x16x32_bf16 v[24:27], a[32:35], a[128:131], v[24:27]
  ds_read_b128 a[68:71], v98 offset:63488
  s_waitcnt lgkmcnt(8)
  v_mfma_f32_16x16x32_bf16 v[28:31], a[36:39], a[128:131], v[28:31]
  v_lshrrev_b32 v8, 4, v1
  s_waitcnt lgkmcnt(7)
  v_mfma_f32_16x16x32_bf16 v[24:27], a[40:43], a[132:135], v[24:27]
  s_mul_i32 s66, s44, 384
  s_waitcnt lgkmcnt(6)
  v_mfma_f32_16x16x32_bf16 v[28:31], a[44:47], a[132:135], v[28:31]
  s_add_u32 s66, s66, 84992
  s_waitcnt lgkmcnt(5)
  v_mfma_f32_16x16x32_bf16 v[24:27], a[48:51], a[136:139], v[24:27]
  v_min_u32 v8, 47, v8
  s_waitcnt lgkmcnt(4)
  v_mfma_f32_16x16x32_bf16 v[28:31], a[52:55], a[136:139], v[28:31]
  v_lshlrev_b32 v9, 3, v8
  s_waitcnt lgkmcnt(3)
  v_mfma_f32_16x16x32_bf16 v[24:27], a[56:59], a[140:143], v[24:27]
  v_add_u32 v10, 152064, v9
  s_waitcnt lgkmcnt(2)
  v_mfma_f32_16x16x32_bf16 v[28:31], a[60:63], a[140:143], v[28:31]
  v_add_u32_e64 v9, s66, v9
  s_waitcnt lgkmcnt(1)
  v_mfma_f32_16x16x32_bf16 v[24:27], a[64:67], a[144:147], v[24:27]
  s_mul_i32 s66, s46, 224
  s_waitcnt lgkmcnt(0)
  v_mfma_f32_16x16x32_bf16 v[28:31], a[68:71], a[144:147], v[28:31]
  s_add_u32 s66, s66, s45
  v_mfma_f32_16x16x32_bf16 v[48:51], a[0:3], a[160:163], v[48:51]
  s_add_u32 s66, s66, s44
  s_mul_i32 s66, s66, 192
  v_mfma_f32_16x16x32_bf16 v[52:55], a[4:7], a[160:163], v[52:55]
  v_lshlrev_b32 v11, 2, v8
  v_add_u32_e64 v11, s66, v11
  v_mfma_f32_16x16x32_bf16 v[48:51], a[8:11], a[164:167], v[48:51]
  v_cvt_pk_bf16_f32 v104, v24, v25
  v_cvt_pk_bf16_f32 v105, v26, v27
  v_mfma_f32_16x16x32_bf16 v[52:55], a[12:15], a[164:167], v[52:55]
  v_cvt_pk_bf16_f32 v106, v28, v29
  v_cvt_pk_bf16_f32 v107, v30, v31
  v_mfma_f32_16x16x32_bf16 v[48:51], a[16:19], a[168:171], v[48:51]
  buffer_store_dwordx4 v[104:107], v0, s[40:43], 0 offen offset:128 sc1
  v_accvgpr_read_b32 v12, a99
  v_mfma_f32_16x16x32_bf16 v[52:55], a[20:23], a[168:171], v[52:55]
  ds_read_b64 v[32:33], v9 offset:0
  ds_read_b64 v[34:35], v9 offset:1536
  v_mfma_f32_16x16x32_bf16 v[48:51], a[24:27], a[172:175], v[48:51]
  ds_read_b64 v[36:37], v9 offset:3072
  ds_read_b64 v[38:39], v9 offset:4608
  v_mfma_f32_16x16x32_bf16 v[52:55], a[28:31], a[172:175], v[52:55]
  ds_read_b64 v[56:57], v10
  v_mfma_f32_16x16x32_bf16 v[48:51], a[32:35], a[176:179], v[48:51]
  v_mfma_f32_16x16x32_bf16 v[52:55], a[36:39], a[176:179], v[52:55]
  v_mfma_f32_16x16x32_bf16 v[48:51], a[40:43], a[180:183], v[48:51]
  v_mfma_f32_16x16x32_bf16 v[52:55], a[44:47], a[180:183], v[52:55]
  s_waitcnt lgkmcnt(0)
  v_mfma_f32_16x16x32_bf16 v[48:51], a[48:51], a[184:187], v[48:51]
  v_add_f32 v32, v32, v34
  v_add_f32_e64 v33, v33, v35
  v_mfma_f32_16x16x32_bf16 v[52:55], a[52:55], a[184:187], v[52:55]
  v_add_f32 v36, v36, v38
  v_add_f32 v37, v37, v39
  v_mfma_f32_16x16x32_bf16 v[48:51], a[56:59], a[188:191], v[48:51]
  v_add_f32 v32, v32, v56
  v_add_f32 v33, v33, v57
  v_mfma_f32_16x16x32_bf16 v[52:55], a[60:63], a[188:191], v[52:55]
  v_add_f32 v32, v32, v36
  v_add_f32 v33, v33, v37
  v_mfma_f32_16x16x32_bf16 v[48:51], a[64:67], a[192:195], v[48:51]
  v_lshlrev_b32_e64 v56, 16, v12
  v_and_b32 v57, 0xffff0000, v12
  v_mfma_f32_16x16x32_bf16 v[52:55], a[68:71], a[192:195], v[52:55]
  v_add_f32 v32, v32, v56
  v_add_f32 v33, v33, v57
  v_mfma_f32_16x16x32_bf16 v[72:75], a[0:3], a[208:211], v[72:75]
  v_cvt_pk_bf16_f32 v13, v32, v33
  s_mov_b32 exec_hi, 0xffff
  buffer_store_dword v13, v11, s[40:43], 0 offen sc1
  s_mov_b32 exec_hi, -1
  v_mfma_f32_16x16x32_bf16 v[76:79], a[4:7], a[208:211], v[76:79]
  v_mfma_f32_16x16x32_bf16 v[72:75], a[8:11], a[212:215], v[72:75]
  v_cvt_pk_bf16_f32 v112, v48, v49
  v_cvt_pk_bf16_f32 v113, v50, v51
  v_mfma_f32_16x16x32_bf16 v[76:79], a[12:15], a[212:215], v[76:79]
  v_cvt_pk_bf16_f32 v114, v52, v53
  v_cvt_pk_bf16_f32 v115, v54, v55
  v_mfma_f32_16x16x32_bf16 v[72:75], a[16:19], a[216:219], v[72:75]
  buffer_store_dwordx4 v[112:115], v2, s[40:43], 0 offen offset:128 sc1
  v_mfma_f32_16x16x32_bf16 v[76:79], a[20:23], a[216:219], v[76:79]
  v_mfma_f32_16x16x32_bf16 v[72:75], a[24:27], a[220:223], v[72:75]
  v_mfma_f32_16x16x32_bf16 v[76:79], a[28:31], a[220:223], v[76:79]
  v_mfma_f32_16x16x32_bf16 v[72:75], a[32:35], a[224:227], v[72:75]
  v_mfma_f32_16x16x32_bf16 v[76:79], a[36:39], a[224:227], v[76:79]
  v_mfma_f32_16x16x32_bf16 v[72:75], a[40:43], a[228:231], v[72:75]
  v_mfma_f32_16x16x32_bf16 v[76:79], a[44:47], a[228:231], v[76:79]
  v_mfma_f32_16x16x32_bf16 v[72:75], a[48:51], a[232:235], v[72:75]
  v_mfma_f32_16x16x32_bf16 v[76:79], a[52:55], a[232:235], v[76:79]
  v_mfma_f32_16x16x32_bf16 v[72:75], a[56:59], a[236:239], v[72:75]
  v_mfma_f32_16x16x32_bf16 v[76:79], a[60:63], a[236:239], v[76:79]
  v_mfma_f32_16x16x32_bf16 v[72:75], a[64:67], a[240:243], v[72:75]
  v_mfma_f32_16x16x32_bf16 v[76:79], a[68:71], a[240:243], v[76:79]
  s_nop 5
  s_nop 0
  s_nop 0
  v_cvt_pk_bf16_f32 v104, v72, v73
  v_cvt_pk_bf16_f32 v105, v74, v75
  v_cvt_pk_bf16_f32 v106, v76, v77
  v_cvt_pk_bf16_f32 v107, v78, v79
  buffer_store_dwordx4 v[104:107], v3, s[40:43], 0 offen offset:128 sc1
L_end:
  s_endpgm
.section .rodata,"a"
.p2align 6
.amdhsa_kernel standalone__modern_conv_block_slak__vision_kernel
  .amdhsa_next_free_vgpr 512
  .amdhsa_next_free_sgpr 102
  .amdhsa_accum_offset 256
  .amdhsa_group_segment_fixed_size 0
  .amdhsa_kernarg_size 72
  .amdhsa_user_sgpr_count 2
  .amdhsa_user_sgpr_kernarg_segment_ptr 1
  .amdhsa_system_sgpr_workgroup_id_x 1
  .amdhsa_float_denorm_mode_32 3
.end_amdhsa_kernel
```
